```python
import torch

def _softmax(x, axis=-1):
    return torch.softmax(x, dim=axis)
def _gelu(x):
    return torch.nn.functional.gelu(x, approximate="tanh")
def _silu(x):
    return torch.nn.functional.silu(x)
def _sigmoid(x):
    return torch.sigmoid(x)
def _layernorm(x, axis=-1, eps=1e-5):
    m = x.mean(dim=axis, keepdim=True)
    v = x.var(dim=axis, keepdim=True, unbiased=False)
    return (x - m) / torch.sqrt(v + eps)
def _scatter_add(tgt, idx, src, axis=0):
    return tgt.clone().index_add_(axis, idx, src)
def _segment_sum(src, seg, n):
    out = torch.zeros((n,) + src.shape[1:], dtype=src.dtype)
    return out.index_add_(0, seg, src)
def _pad(x, pw):
    flat = tuple(v for pair in reversed(pw) for v in pair)
    return torch.nn.functional.pad(x, flat)

kernel_name = 'gated_mix__ssm_conv_s5__ssm_conv_s4__prompt'

def setup_inputs():

    _w = (lambda a: (lambda t: t.to(torch.bfloat16) if t.is_floating_point() else t)(torch.as_tensor(a)))
    def _A_setup():
        B, S, D = 1, 2048, 512
        P = D
        Lambda_re = -0.5 * (lambda _x: torch.exp(torch.as_tensor(_x)))((lambda *s: torch.randn(*s, dtype=torch.bfloat16) * 0.2)(P))
        Lambda_im = (lambda *s: torch.randn(*s, dtype=torch.bfloat16) * 0.4)(P) * 1.0
        B_re = (lambda *s: torch.randn(*s, dtype=torch.bfloat16) * 0.2)(P, D) * (D ** -0.5)
        B_im = (lambda *s: torch.randn(*s, dtype=torch.bfloat16) * 0.2)(P, D) * (D ** -0.5)
        C_re = (lambda *s: torch.randn(*s, dtype=torch.bfloat16) * 0.2)(D, P) * (P ** -0.5)
        C_im = (lambda *s: torch.randn(*s, dtype=torch.bfloat16) * 0.2)(D, P) * (P ** -0.5)
        log_dt = (lambda *s: torch.randn(*s, dtype=torch.bfloat16) * 0.2)(P) * 0.3 - 2.0
        Dskip = (lambda *s: torch.randn(*s, dtype=torch.bfloat16) * 0.05)(D)
        return {
            "x": _w((lambda *s: torch.randn(*s, dtype=torch.bfloat16) * 0.05)(B, S, D)),
            "Lambda_re": _w(Lambda_re),
            "Lambda_im": _w(Lambda_im),
            "B_re": _w(B_re),
            "B_im": _w(B_im),
            "C_re": _w(C_re),
            "C_im": _w(C_im),
            "log_dt": _w(log_dt),
            "Dskip": _w(Dskip),
        }
    _A_in = _A_setup()

    def _B_setup():
        B, L, D, N = 1, 2048, 512, 128
        A_re = -(lambda _x: torch.exp(torch.as_tensor(_x)))((lambda *s: torch.randn(*s, dtype=torch.bfloat16) * 3.2)(D, N))
        A_im = torch.pi * (lambda *s: torch.randn(*s, dtype=torch.bfloat16) * 0.05)(D, N)
        B_re = (lambda *s: torch.randn(*s, dtype=torch.bfloat16) * 0.1)(D, N)
        B_im = (lambda *s: torch.randn(*s, dtype=torch.bfloat16) * 0.1)(D, N)
        C_re = (lambda *s: torch.randn(*s, dtype=torch.bfloat16) * 0.1)(D, N)
        C_im = (lambda *s: torch.randn(*s, dtype=torch.bfloat16) * 0.1)(D, N)
        log_dt = (lambda *s: torch.randn(*s, dtype=torch.bfloat16) * 0.05)(D) * 0.5 - 4.0
        Dskip = (lambda *s: torch.randn(*s, dtype=torch.bfloat16) * 0.05)(D)
        return {
            "u": _w((lambda *s: torch.randn(*s, dtype=torch.bfloat16) * 0.05)(B, L, D)),
            "A_re": _w(A_re),
            "A_im": _w(A_im),
            "B_re": _w(B_re),
            "B_im": _w(B_im),
            "C_re": _w(C_re),
            "C_im": _w(C_im),
            "log_dt": _w(log_dt),
            "Dskip": _w(Dskip),
        }
    _B_in = _B_setup()

    return {
        "A_x": _A_in["x"],
        "A_Lambda_re": _A_in["Lambda_re"],
        "A_Lambda_im": _A_in["Lambda_im"],
        "A_B_re": _A_in["B_re"],
        "A_B_im": _A_in["B_im"],
        "A_C_re": _A_in["C_re"],
        "A_C_im": _A_in["C_im"],
        "A_log_dt": _A_in["log_dt"],
        "A_Dskip": _A_in["Dskip"],
        "B_u": _B_in["u"],
        "B_A_re": _B_in["A_re"],
        "B_A_im": _B_in["A_im"],
        "B_B_re": _B_in["B_re"],
        "B_B_im": _B_in["B_im"],
        "B_C_re": _B_in["C_re"],
        "B_C_im": _B_in["C_im"],
        "B_log_dt": _B_in["log_dt"],
        "B_Dskip": _B_in["Dskip"],
        "gate_w": _w((lambda *s: torch.randn(*s, dtype=torch.bfloat16) * 0.05)(512) * 16.0),
    }

def reference(A_x, A_Lambda_re, A_Lambda_im, A_B_re, A_B_im, A_C_re, A_C_im, A_log_dt, A_Dskip, B_u, B_A_re, B_A_im, B_B_re, B_B_im, B_C_re, B_C_im, B_log_dt, B_Dskip, gate_w):
    def _A_ref(x, Lambda_re, Lambda_im, B_re, B_im, C_re, C_im, log_dt, Dskip):
        Bsz, L, H = x.shape
        Lam = Lambda_re + 1j * Lambda_im
        Bmat = B_re + 1j * B_im
        Cmat = C_re + 1j * C_im
        dt = torch.exp(log_dt)
        Lam_bar = torch.exp(dt * Lam)
        B_bar = ((Lam_bar - 1.0) / Lam)[:, None] * Bmat
        Bu = torch.einsum("bld,pd->blp", x + 0j, B_bar)
        h = torch.zeros_like(Bu[:, 0, :])
        hs = []
        for t in range(L):
            h = Lam_bar[None, :] * h + Bu[:, t, :]
            hs.append(h)
        hseq = torch.stack(hs, 1)
        y = 2.0 * torch.einsum("blp,dp->bld", hseq, Cmat).real + x * Dskip[None, None, :]
        return y

    def _B_ref(u, A_re, A_im, B_re, B_im, C_re, C_im, log_dt, Dskip):
        Bsz, L, D = u.shape
        dt = torch.exp(log_dt)[:, None]
        A = A_re + 1j * A_im
        Bc = B_re + 1j * B_im
        Cc = C_re + 1j * C_im
        logdA = dt * A
        dB = dt * Bc
        l = (lambda x, dt: x.to(dt))(torch.arange(L), A_re.dtype)
        P = torch.exp(logdA[:, :, None] * l[None, None, :])
        K = torch.einsum("dn,dnl,dn->dl", Cc, P, dB).real
        L2 = 2 * L
        Kp = _pad(K, ((0, 0), (0, L)))
        up = (lambda x, *d: x.permute(*d))(u, 0, 2, 1)
        up = _pad(up, ((0, 0), (0, 0), (0, L)))
        Kf = (lambda x, axes=(-2,-1): torch.fft.rfft2(x.float(), dim=axes))(Kp[:, None, :], axes=(-2, -1))
        Uf = (lambda x, axes=(-2,-1): torch.fft.rfft2(x.float(), dim=axes))(up[:, :, None, :], axes=(-2, -1))
        Yf = Uf * Kf[None, :, :, :]
        y = (lambda x, s, axes=(-2,-1): torch.fft.irfft2(x, s=s, dim=axes).to(torch.bfloat16))(Yf, (1, L2), axes=(-2, -1))[:, :, 0, :L]
        y = (lambda x, *d: x.permute(*d))(y, 0, 2, 1) + u * Dskip[None, None, :]
        return y

    x = A_x
    g = _sigmoid((x * gate_w).sum(-1, keepdims=True))
    a = _A_ref(x, A_Lambda_re, A_Lambda_im, A_B_re, A_B_im, A_C_re, A_C_im, A_log_dt, A_Dskip)
    b = _B_ref(x, B_A_re, B_A_im, B_B_re, B_B_im, B_C_re, B_C_im, B_log_dt, B_Dskip)
    return g * a + (1 - g) * b
```

```asm
; @launch grid=(256,1,1) block=(512,1,1) lds=163360
.amdgcn_target "amdgcn-amd-amdhsa--gfx950"
.text
.globl gated_mix__ssm_conv_s5__ssm_conv_s4__prompt_kernel
.p2align 8
.type gated_mix__ssm_conv_s5__ssm_conv_s4__prompt_kernel,@function
gated_mix__ssm_conv_s5__ssm_conv_s4__prompt_kernel:
    s_cmp_ge_u32 s2, 256
    s_cbranch_scc1 gated_mix__ssm_conv_s5__ssm_conv_s4__prompt_kernel_END
    s_load_dwordx16 s[16:31], s[0:1], 0
    s_load_dwordx16 s[32:47], s[0:1], 64
    s_load_dwordx8 s[48:55], s[0:1], 128
    s_load_dwordx4 s[56:59], s[0:1], 160
    s_memrealtime s[98:99]
    s_getpc_b64 s[12:13]
gated_mix__ssm_conv_s5__ssm_conv_s4__prompt_kernel_PC:
    v_lshrrev_b32 v2, 6, v0
    v_and_b32 v1, 63, v0
    v_readfirstlane_b32 s3, v2
    s_and_b32 s4, s2, 7
    s_lshr_b32 s5, s2, 3
    s_cmp_lg_u32 s3, 7
    s_cbranch_scc1 gated_mix__ssm_conv_s5__ssm_conv_s4__prompt_kernel_NPF1
    s_and_b32 s11, s5, 3
    s_lshl_b32 s11, s11, 13
    v_lshlrev_b32 v2, 7, v1
    v_add_u32 v2, s11, v2
    v_min_u32 v2, gated_mix__ssm_conv_s5__ssm_conv_s4__prompt_kernel_END-gated_mix__ssm_conv_s5__ssm_conv_s4__prompt_kernel_PC, v2
    global_load_dword v3, v2, s[12:13]
gated_mix__ssm_conv_s5__ssm_conv_s4__prompt_kernel_NPF1:
    s_and_b32 s11, s5, 1
    s_lshl_b32 s6, s4, 1
    s_add_u32 s6, s6, s11
    s_lshr_b32 s7, s5, 1
    s_lshr_b32 s9, s5, 2
    s_and_b32 s14, s5, 3
    s_lshl_b32 s8, s4, 2
    s_add_u32 s8, s8, s14
    s_lshl_b32 s11, s3, 10
    s_add_u32 s14, s11, 131072
    s_add_u32 s15, s11, 139008
    s_cmp_lt_u32 s3, 3
    s_cselect_b32 s14, s14, s15
    s_cmp_eq_u32 s3, 6
    s_cselect_b32 s14, 153088, s14
    s_cmp_eq_u32 s3, 7
    s_cselect_b32 s14, 157728, s14
    v_lshl_add_u32 v2, v1, 4, s14
    v_mov_b32 v4, 0
    v_mov_b32 v5, 0
    v_mov_b32 v6, 0
    v_mov_b32 v7, 0
    ds_write_b128 v2, v[4:7]
    s_waitcnt lgkmcnt(0)
    s_or_b32 s11, s2, s3
    s_cmp_lg_u32 s11, 0
    s_cbranch_scc1 gated_mix__ssm_conv_s5__ssm_conv_s4__prompt_kernel_NN2
    s_or_b32 s11, s98, 1
    v_mov_b32 v5, s11
    s_mov_b64 exec, 1
    global_store_dword v4, v5, s[56:57] sc1
    s_mov_b64 exec, -1
gated_mix__ssm_conv_s5__ssm_conv_s4__prompt_kernel_NN2:
    s_getreg_b32 s0, hwreg(HW_REG_XCC_ID, 0, 4)
    s_mul_i32 s1, s0, s0
    s_lshl_b32 s1, s1, 9
    s_add_u32 s0, s0, s1
    s_lshl_b32 s0, s0, 6
    s_add_u32 s0, s0, 1
    s_lshl_b32 s1, s4, 4
    s_add_u32 s1, s1, 128
    s_lshl_b32 s0, s0, 5
    s_cmp_ge_u32 s3, 4
    s_cbranch_scc1 gated_mix__ssm_conv_s5__ssm_conv_s4__prompt_kernel_S4
    s_mov_b32 s60, s16
    s_and_b32 s61, s17, 0xffff
    s_mov_b32 s62, 2097152
    s_mov_b32 s63, 0x20000
    s_and_b32 s11, s3, 1
    s_cmp_eq_u32 s11, 0
    s_cselect_b32 s64, s22, s24
    s_cselect_b32 s65, s23, s25
    s_cselect_b32 s68, s26, s28
    s_cselect_b32 s69, s27, s29
    s_and_b32 s65, s65, 0xffff
    s_mov_b32 s66, 524288
    s_mov_b32 s67, 0x20000
    v_lshrrev_b32 v32, 4, v1
    v_and_b32 v8, 15, v1
    v_xor_b32 v8, v8, v32
    v_lshlrev_b32 v8, 4, v8
    v_lshl_add_u32 v8, v32, 10, v8
    v_xor_b32 v9, 64, v8
    v_xor_b32 v10, 128, v8
    v_xor_b32 v11, 192, v8
    v_and_b32 v32, 31, v1
    s_lshl_b32 s14, s7, 6
    v_lshl_add_u32 v33, v32, 1, s14
    v_lshrrev_b32 v34, 5, v1
    s_lshl_b32 s14, s6, 7
    s_lshl_b32 s15, s3, 5
    s_add_u32 s14, s14, s15
    s_lshl_b32 s36, s14, 10
    s_lshl_b32 s15, s7, 11
    s_add_u32 s15, s15, s36
    v_lshlrev_b32 v35, 5, v32
    v_lshl_add_u32 v36, v34, 10, v35
    v_add_u32 v36, s15, v36
    v_mov_b32 v42, 0
    v_writelane_b32 v42, s1, 1
    global_load_ushort v46, v33, s[30:31]
    global_load_ushort v44, v33, s[18:19]
    global_load_ushort v45, v33, s[20:21]
    s_add_u32 s11, s6, s7
    s_and_b32 s11, s11, 3
    s_lshl_b32 s37, s11, 8
    s_add_u32 s38, s37, 256
    s_and_b32 s38, s38, 1023
    s_add_u32 s39, s37, 512
    s_and_b32 s39, s39, 1023
    s_add_u32 s40, s37, 768
    s_and_b32 s40, s40, 1023
    s_lshr_b32 s11, s3, 1
    s_lshl_b32 s41, s7, 15
    s_lshl_b32 s14, s11, 14
    s_add_u32 s41, s41, s14
    s_lshl_b32 s42, s11, 12
    s_and_b32 s11, s3, 1
    s_lshl_b32 s11, s11, 13
    s_add_u32 s42, s42, s11
    s_lshl_b32 s43, s3, 14
    s_add_u32 s43, s43, 65536
    v_lshrrev_b32 v37, 4, v1
    v_and_b32 v38, 1, v37
    v_lshlrev_b32 v38, 3, v38
    v_add_u32 v38, v38, v34
    v_sub_u32 v38, v38, v37
    v_lshlrev_b32 v38, 10, v38
    v_add_u32 v12, v8, v38
    v_add_u32 v13, v9, v38
    v_add_u32 v14, v10, v38
    v_add_u32 v15, v11, v38
    global_load_dwordx4 v[76:79], v36, s[16:17]
    global_load_dwordx4 v[80:83], v36, s[16:17] offset:16
    global_load_dwordx4 v[84:87], v35, s[52:53]
    global_load_dwordx4 v[88:91], v35, s[52:53] offset:16
    s_barrier
    s_add_u32 s14, s41, s37
    s_add_u32 m0, s42, 0
    s_add_u32 s15, s14, 0
    buffer_load_dwordx4 v8, s[64:67], s15 offen lds
    v_and_b32 v37, 15, v1
    v_xor_b32 v37, v37, v34
    v_lshlrev_b32 v37, 4, v37
    v_lshl_add_u32 v16, v32, 8, v37
    v_xor_b32 v17, 32, v16
    s_add_u32 s14, s41, s37
    s_add_u32 m0, s42, 1024
    s_add_u32 s15, s14, 4096
    buffer_load_dwordx4 v9, s[64:67], s15 offen lds
    v_xor_b32 v18, 64, v16
    v_xor_b32 v19, 96, v16
    v_xor_b32 v20, 128, v16
    v_xor_b32 v21, 160, v16
    v_xor_b32 v22, 192, v16
    s_add_u32 s14, s41, s37
    s_add_u32 m0, s42, 2048
    s_add_u32 s15, s14, 8192
    buffer_load_dwordx4 v10, s[64:67], s15 offen lds
    v_xor_b32 v23, 224, v16
    v_add_u32 v24, s43, v16
    v_add_u32 v25, s43, v17
    v_add_u32 v26, s43, v18
    v_add_u32 v27, s43, v19
    s_add_u32 s14, s41, s37
    s_add_u32 m0, s42, 3072
    s_add_u32 s15, s14, 12288
    buffer_load_dwordx4 v11, s[64:67], s15 offen lds
    v_add_u32 v28, s43, v20
    v_add_u32 v29, s43, v21
    v_add_u32 v30, s43, v22
    v_add_u32 v31, s43, v23
    v_mov_b32 v40, 153088
    s_add_u32 s14, s36, s37
    s_add_u32 m0, s43, 0
    s_add_u32 s15, s14, 0
    buffer_load_dwordx4 v12, s[60:63], s15 offen lds
    s_lshl_b32 s11, s3, 2
    v_add_u32 v41, s11, v40
    s_lshl_b32 s11, s3, 1
    v_add_u32 v49, s11, v34
    s_and_b32 s69, s69, 0xffff
    s_add_u32 m0, s43, 1024
    s_add_u32 s15, s14, 16384
    buffer_load_dwordx4 v13, s[60:63], s15 offen lds
    s_mov_b32 s70, 524288
    s_mov_b32 s71, 0x20000
    s_lshl_b32 s45, s5, 1
    s_lshr_b32 s46, s3, 1
    s_add_u32 s45, s45, s46
    s_add_u32 m0, s43, 2048
    s_add_u32 s15, s14, 2048
    buffer_load_dwordx4 v14, s[60:63], s15 offen lds
    s_lshl_b32 s45, s45, 13
    v_lshlrev_b32 v218, 7, v1
    s_lshl_b32 s46, s7, 13
    s_add_u32 s46, s46, 8388608
    v_lshl_add_u32 v216, v1, 4, s46
    s_add_u32 m0, s43, 3072
    s_add_u32 s15, s14, 18432
    buffer_load_dwordx4 v15, s[60:63], s15 offen lds
    s_lshl_b32 s46, s6, 9
    v_add_u32 v217, s46, v216
    s_lshl_b32 s46, s3, 11
    v_add_u32 v216, s46, v216
    v_lshlrev_b32 v220, 3, v32
    s_add_u32 m0, s43, 4096
    s_add_u32 s15, s14, 4096
    buffer_load_dwordx4 v12, s[60:63], s15 offen lds
    v_add_u32 v220, 162336, v220
    s_lshl_b32 s46, s3, 8
    v_add_u32 v219, s46, v220
    s_lshl_b32 s46, s6, 2
    s_add_u32 s46, s46, s3
    s_add_u32 m0, s43, 5120
    s_add_u32 s15, s14, 20480
    buffer_load_dwordx4 v13, s[60:63], s15 offen lds
    s_lshl_b32 s46, s46, 4
    s_add_u32 s46, s46, s7
    s_lshl_b32 s46, s46, 4
    s_add_u32 s46, s46, 8523776
    v_mov_b32 v2, s46
    s_add_u32 m0, s43, 6144
    s_add_u32 s15, s14, 6144
    buffer_load_dwordx4 v14, s[60:63], s15 offen lds
    s_mov_b32 s72, s26
    s_and_b32 s73, s27, 0xffff
    s_mov_b32 s74, 524288
    s_mov_b32 s75, 0x20000
    s_lshl_b32 s46, s6, 2
    s_add_u32 m0, s43, 7168
    s_add_u32 s15, s14, 22528
    buffer_load_dwordx4 v15, s[60:63], s15 offen lds
    s_add_u32 s46, s46, s3
    s_lshl_b32 s46, s46, 5
    s_add_u32 s46, s46, s7
    s_lshl_b32 s46, s46, 11
    s_add_u32 s34, s46, 2097152
    v_bfe_u32 v221, v1, 4, 1
    v_lshlrev_b32 v221, 8, v221
    v_and_or_b32 v221, v1, 15, v221
    v_lshl_add_u32 v221, v221, 7, s34
    s_lshl_b32 s25, s9, 16
    s_lshr_b32 s46, s3, 1
    s_lshl_b32 s22, s46, 15
    s_add_u32 s22, s22, s25
    s_lshl_b32 s23, s46, 13
    s_lshl_b32 s24, s46, 8
    s_add_u32 s24, s24, s25
    s_and_b32 s46, s3, 1
    s_lshl_b32 s46, s46, 14
    s_add_u32 s23, s23, s46
    s_lshl_b32 s46, s3, 14
    s_add_u32 s25, s25, s46
    s_lshl_b32 s44, s3, 12
    s_waitcnt vmcnt(12)
    s_add_u32 s14, s41, s38
    s_add_u32 m0, s42, 16384
    s_add_u32 s15, s14, 0
    buffer_load_dwordx4 v8, s[64:67], s15 offen lds
    v_lshlrev_b32 v46, 16, v46
    v_lshlrev_b32 v44, 16, v44
    v_mul_f32 v46, 0x3fb8aa3b, v46
    v_lshlrev_b32 v45, 16, v45
    s_add_u32 s14, s41, s38
    s_add_u32 m0, s42, 17408
    s_add_u32 s15, s14, 4096
    buffer_load_dwordx4 v9, s[64:67], s15 offen lds
    v_exp_f32 v46, v46
    s_nop 0
    v_cvt_pk_bf16_f32 v46, v46, v46
    v_lshlrev_b32 v46, 16, v46
    v_mul_f32 v47, v46, v44
    s_add_u32 s14, s41, s38
    s_add_u32 m0, s42, 18432
    s_add_u32 s15, s14, 8192
    buffer_load_dwordx4 v10, s[64:67], s15 offen lds
    v_mul_f32 v48, v46, v45
    v_mul_f32 v47, 0x3fb8aa3b, v47
    v_mul_f32 v48, 0x3e22f983, v48
    v_mul_f32 v70, 1.0, v47
    s_add_u32 s14, s41, s38
    s_add_u32 m0, s42, 19456
    s_add_u32 s15, s14, 12288
    buffer_load_dwordx4 v11, s[64:67], s15 offen lds
    v_mul_f32 v71, 1.0, v48
    v_exp_f32 v70, v70
    v_fract_f32 v71, v71
    v_cos_f32 v52, v71
    s_add_u32 s14, s36, s38
    s_add_u32 m0, s43, 8192
    s_add_u32 s15, s14, 0
    buffer_load_dwordx4 v12, s[60:63], s15 offen lds
    v_sin_f32 v53, v71
    v_mul_f32 v52, v52, v70
    v_mul_f32 v53, v53, v70
    v_mul_f32 v72, 0x41000000, v47
    s_add_u32 m0, s43, 9216
    s_add_u32 s15, s14, 16384
    buffer_load_dwordx4 v13, s[60:63], s15 offen lds
    v_mul_f32 v73, 0x41000000, v48
    v_exp_f32 v72, v72
    v_fract_f32 v73, v73
    v_cos_f32 v54, v73
    s_add_u32 m0, s43, 10240
    s_add_u32 s15, s14, 2048
    buffer_load_dwordx4 v14, s[60:63], s15 offen lds
    v_sin_f32 v55, v73
    v_mul_f32 v54, v54, v72
    v_mul_f32 v55, v55, v72
    v_mul_f32 v70, 0x41800000, v47
    s_add_u32 m0, s43, 11264
    s_add_u32 s15, s14, 18432
    buffer_load_dwordx4 v15, s[60:63], s15 offen lds
    v_mul_f32 v71, 0x41800000, v48
    v_exp_f32 v70, v70
    v_fract_f32 v71, v71
    v_cos_f32 v56, v71
    s_add_u32 m0, s43, 12288
    s_add_u32 s15, s14, 4096
    buffer_load_dwordx4 v12, s[60:63], s15 offen lds
    v_sin_f32 v57, v71
    v_mul_f32 v56, v56, v70
    v_mul_f32 v57, v57, v70
    v_mul_f32 v70, v44, v44
    s_add_u32 m0, s43, 13312
    s_add_u32 s15, s14, 20480
    buffer_load_dwordx4 v13, s[60:63], s15 offen lds
    v_fmac_f32 v70, v45, v45
    v_rcp_f32 v70, v70
    v_add_f32 v71, -1.0, v52
    v_mul_f32 v58, v71, v44
    s_add_u32 m0, s43, 14336
    s_add_u32 s15, s14, 6144
    buffer_load_dwordx4 v14, s[60:63], s15 offen lds
    v_fmac_f32 v58, v53, v45
    v_mul_f32 v59, v53, v44
    v_fma_f32 v59, -v71, v45, v59
    v_add_f32 v70, v70, v70
    s_add_u32 m0, s43, 15360
    s_add_u32 s15, s14, 22528
    buffer_load_dwordx4 v15, s[60:63], s15 offen lds
    v_mul_f32 v58, v58, v70
    v_mul_f32 v59, v59, v70
    v_mul_f32 v196, v58, v52
    v_mul_f32 v197, v58, v53
    v_fma_f32 v196, -v59, v53, v196
    v_fmac_f32 v197, v59, v52
    s_setprio 2
    s_waitcnt vmcnt(12)
    v_mov_b32 v32, 1
    ds_write_b32 v41, v32
    ds_read_b128 v[164:167], v24 offset:0
    ds_read_b128 v[168:171], v25 offset:0
    ds_read_b128 v[172:175], v26 offset:0
    ds_read_b128 v[176:179], v27 offset:0
    ds_read_b128 v[180:183], v28 offset:0
    ds_read_b128 v[184:187], v29 offset:0
    ds_read_b128 v[188:191], v30 offset:0
    ds_read_b128 v[192:195], v31 offset:0
    s_mov_b32 s11, 1048576
gated_mix__ssm_conv_s5__ssm_conv_s4__prompt_kernel_SW4:
    ds_read_b128 v[32:35], v40 offset:0
    ds_read_b128 v[124:127], v16 offset:0
    ds_read_b128 v[128:131], v16 offset:8192
    ds_read_b128 v[132:135], v17 offset:0
    ds_read_b128 v[136:139], v17 offset:8192
    s_waitcnt lgkmcnt(4)
    v_min3_u32 v32, v32, v33, v34
    v_min_u32 v32, v32, v35
    s_sub_u32 s11, s11, 1
    v_readfirstlane_b32 s14, v32
    s_cmp_eq_u32 s11, 0
    s_cbranch_scc1 gated_mix__ssm_conv_s5__ssm_conv_s4__prompt_kernel_SD5
    s_cmp_lt_u32 s14, 1
    s_cbranch_scc1 gated_mix__ssm_conv_s5__ssm_conv_s4__prompt_kernel_SW4
gated_mix__ssm_conv_s5__ssm_conv_s4__prompt_kernel_SD5:
    ds_read_b128 v[140:143], v18 offset:0
    ds_read_b128 v[144:147], v18 offset:8192
    s_waitcnt lgkmcnt(4)
    v_mfma_f32_32x32x16_bf16 v[92:107], v[164:167], v[124:127], 0
    v_mfma_f32_32x32x16_bf16 v[108:123], v[164:167], v[128:131], 0
    s_add_u32 s14, s41, s39
    s_add_u32 m0, s42, 32768
    s_add_u32 s15, s14, 0
    buffer_load_dwordx4 v8, s[64:67], s15 offen lds
    s_add_u32 s14, s41, s39
    s_add_u32 m0, s42, 33792
    s_add_u32 s15, s14, 4096
    buffer_load_dwordx4 v9, s[64:67], s15 offen lds
    v_mul_f32 v198, v196, v52
    v_mul_f32 v199, v196, v53
    v_fma_f32 v198, -v197, v53, v198
    v_fmac_f32 v199, v197, v52
    v_mul_f32 v200, v198, v52
    v_mul_f32 v201, v198, v53
    v_fma_f32 v200, -v199, v53, v200
    v_fmac_f32 v201, v199, v52
    v_mul_f32 v202, v200, v52
    v_mul_f32 v203, v200, v53
    v_fma_f32 v202, -v201, v53, v202
    v_fmac_f32 v203, v201, v52
    v_mul_f32 v204, v202, v52
    v_mul_f32 v205, v202, v53
    v_fma_f32 v204, -v203, v53, v204
    v_fmac_f32 v205, v203, v52
    ds_read_b128 v[124:127], v19 offset:0
    ds_read_b128 v[128:131], v19 offset:8192
    s_waitcnt lgkmcnt(4)
    v_mfma_f32_32x32x16_bf16 v[92:107], v[168:171], v[132:135], v[92:107]
    v_mfma_f32_32x32x16_bf16 v[108:123], v[168:171], v[136:139], v[108:123]
    s_add_u32 s14, s41, s39
    s_add_u32 m0, s42, 34816
    s_add_u32 s15, s14, 8192
    buffer_load_dwordx4 v10, s[64:67], s15 offen lds
    s_add_u32 s14, s41, s39
    s_add_u32 m0, s42, 35840
    s_add_u32 s15, s14, 12288
    buffer_load_dwordx4 v11, s[64:67], s15 offen lds
    v_mul_f32 v206, v204, v52
    v_mul_f32 v207, v204, v53
    v_fma_f32 v206, -v205, v53, v206
    v_fmac_f32 v207, v205, v52
    v_mul_f32 v208, v206, v52
    v_mul_f32 v209, v206, v53
    v_fma_f32 v208, -v207, v53, v208
    v_fmac_f32 v209, v207, v52
    v_mul_f32 v210, v208, v52
    v_mul_f32 v211, v208, v53
    v_fma_f32 v210, -v209, v53, v210
    v_fmac_f32 v211, v209, v52
    v_cvt_f32_u32 v72, v49
    v_mul_f32 v72, 0x41800000, v72
    ds_read_b128 v[132:135], v20 offset:0
    ds_read_b128 v[136:139], v20 offset:8192
    s_waitcnt lgkmcnt(4)
    v_mfma_f32_32x32x16_bf16 v[92:107], v[172:175], v[140:143], v[92:107]
    v_mfma_f32_32x32x16_bf16 v[108:123], v[172:175], v[144:147], v[108:123]
    s_add_u32 s14, s36, s39
    s_add_u32 m0, s43, 0
    s_add_u32 s15, s14, 0
    buffer_load_dwordx4 v12, s[60:63], s15 offen lds
    s_add_u32 s14, s36, s39
    s_add_u32 m0, s43, 1024
    s_add_u32 s15, s14, 16384
    buffer_load_dwordx4 v13, s[60:63], s15 offen lds
    v_add_f32 v73, 0x41000000, v72
    v_mul_f32 v70, v72, v47
    v_mul_f32 v71, v72, v48
    v_exp_f32 v70, v70
    v_fract_f32 v71, v71
    v_cos_f32 v64, v71
    v_sin_f32 v66, v71
    v_mul_f32 v64, v64, v70
    ds_read_b128 v[140:143], v21 offset:0
    ds_read_b128 v[144:147], v21 offset:8192
    s_waitcnt lgkmcnt(4)
    v_mfma_f32_32x32x16_bf16 v[92:107], v[176:179], v[124:127], v[92:107]
    v_mfma_f32_32x32x16_bf16 v[108:123], v[176:179], v[128:131], v[108:123]
    s_add_u32 s14, s36, s39
    s_add_u32 m0, s43, 2048
    s_add_u32 s15, s14, 2048
    buffer_load_dwordx4 v14, s[60:63], s15 offen lds
    s_add_u32 s14, s36, s39
    s_add_u32 m0, s43, 3072
    s_add_u32 s15, s14, 18432
    buffer_load_dwordx4 v15, s[60:63], s15 offen lds
    v_mul_f32 v66, v66, v70
    v_mul_f32 v74, v73, v47
    v_mul_f32 v75, v73, v48
    v_exp_f32 v74, v74
    v_fract_f32 v75, v75
    v_cos_f32 v65, v75
    v_sin_f32 v67, v75
    v_mul_f32 v65, v65, v74
    ds_read_b128 v[124:127], v22 offset:0
    ds_read_b128 v[128:131], v22 offset:8192
    s_waitcnt lgkmcnt(4)
    v_mfma_f32_32x32x16_bf16 v[92:107], v[180:183], v[132:135], v[92:107]
    v_mfma_f32_32x32x16_bf16 v[108:123], v[180:183], v[136:139], v[108:123]
    s_add_u32 s14, s36, s39
    s_add_u32 m0, s43, 4096
    s_add_u32 s15, s14, 4096
    buffer_load_dwordx4 v12, s[60:63], s15 offen lds
    v_mul_f32 v67, v67, v74
    v_mov_b32 v50, 0
    v_lshlrev_b32 v70, 16, v76
    v_and_b32 v71, 0xffff0000, v76
    v_lshlrev_b32 v72, 16, v84
    v_and_b32 v73, 0xffff0000, v84
    v_mul_f32 v70, v70, v72
    v_mul_f32 v71, v71, v73
    v_cvt_pk_bf16_f32 v70, v70, v71
    ds_read_b128 v[132:135], v23 offset:0
    ds_read_b128 v[136:139], v23 offset:8192
    s_waitcnt lgkmcnt(4)
    v_mfma_f32_32x32x16_bf16 v[92:107], v[184:187], v[140:143], v[92:107]
    v_mfma_f32_32x32x16_bf16 v[108:123], v[184:187], v[144:147], v[108:123]
    s_add_u32 s14, s36, s39
    s_add_u32 m0, s43, 5120
    s_add_u32 s15, s14, 20480
    buffer_load_dwordx4 v13, s[60:63], s15 offen lds
    v_lshlrev_b32 v71, 16, v70
    v_and_b32 v70, 0xffff0000, v70
    v_add_f32 v50, v50, v71
    v_add_f32 v50, v50, v70
    v_lshlrev_b32 v70, 16, v77
    v_and_b32 v71, 0xffff0000, v77
    v_lshlrev_b32 v72, 16, v85
    v_and_b32 v73, 0xffff0000, v85
    s_waitcnt lgkmcnt(2)
    v_mfma_f32_32x32x16_bf16 v[92:107], v[188:191], v[124:127], v[92:107]
    v_mfma_f32_32x32x16_bf16 v[108:123], v[188:191], v[128:131], v[108:123]
    s_add_u32 s14, s36, s39
    s_add_u32 m0, s43, 6144
    s_add_u32 s15, s14, 6144
    buffer_load_dwordx4 v14, s[60:63], s15 offen lds
    v_mul_f32 v70, v70, v72
    v_mul_f32 v71, v71, v73
    v_cvt_pk_bf16_f32 v70, v70, v71
    v_lshlrev_b32 v71, 16, v70
    v_and_b32 v70, 0xffff0000, v70
    v_add_f32 v50, v50, v71
    v_add_f32 v50, v50, v70
    v_lshlrev_b32 v70, 16, v78
    v_and_b32 v71, 0xffff0000, v78
    s_waitcnt lgkmcnt(0)
    v_mfma_f32_32x32x16_bf16 v[92:107], v[192:195], v[132:135], v[92:107]
    v_mfma_f32_32x32x16_bf16 v[108:123], v[192:195], v[136:139], v[108:123]
    s_add_u32 s14, s36, s39
    s_add_u32 m0, s43, 7168
    s_add_u32 s15, s14, 22528
    buffer_load_dwordx4 v15, s[60:63], s15 offen lds
    v_lshlrev_b32 v72, 16, v86
    v_and_b32 v73, 0xffff0000, v86
    v_mul_f32 v70, v70, v72
    v_mul_f32 v71, v71, v73
    v_cvt_pk_bf16_f32 v70, v70, v71
    v_lshlrev_b32 v71, 16, v70
    v_and_b32 v70, 0xffff0000, v70
    v_add_f32 v50, v50, v71
    v_add_f32 v50, v50, v70
    s_waitcnt vmcnt(12)
    v_mov_b32 v32, 2
    ds_write_b32 v41, v32
    ds_read_b128 v[164:167], v24 offset:8192
    ds_read_b128 v[168:171], v25 offset:8192
    ds_read_b128 v[172:175], v26 offset:8192
    ds_read_b128 v[176:179], v27 offset:8192
    ds_read_b128 v[180:183], v28 offset:8192
    ds_read_b128 v[184:187], v29 offset:8192
    ds_read_b128 v[188:191], v30 offset:8192
    ds_read_b128 v[192:195], v31 offset:8192
    s_mov_b32 s11, 1048576
gated_mix__ssm_conv_s5__ssm_conv_s4__prompt_kernel_SW6:
    ds_read_b128 v[32:35], v40 offset:0
    ds_read_b128 v[124:127], v16 offset:16384
    ds_read_b128 v[128:131], v16 offset:24576
    ds_read_b128 v[132:135], v17 offset:16384
    ds_read_b128 v[136:139], v17 offset:24576
    s_waitcnt lgkmcnt(4)
    v_min3_u32 v32, v32, v33, v34
    v_min_u32 v32, v32, v35
    s_sub_u32 s11, s11, 1
    v_readfirstlane_b32 s14, v32
    s_cmp_eq_u32 s11, 0
    s_cbranch_scc1 gated_mix__ssm_conv_s5__ssm_conv_s4__prompt_kernel_SD7
    s_cmp_lt_u32 s14, 2
    s_cbranch_scc1 gated_mix__ssm_conv_s5__ssm_conv_s4__prompt_kernel_SW6
gated_mix__ssm_conv_s5__ssm_conv_s4__prompt_kernel_SD7:
    ds_read_b128 v[140:143], v18 offset:16384
    ds_read_b128 v[144:147], v18 offset:24576
    s_waitcnt lgkmcnt(4)
    v_mfma_f32_32x32x16_bf16 v[92:107], v[164:167], v[124:127], v[92:107]
    v_mfma_f32_32x32x16_bf16 v[108:123], v[164:167], v[128:131], v[108:123]
    s_add_u32 s14, s41, s40
    s_add_u32 m0, s42, 49152
    s_add_u32 s15, s14, 0
    buffer_load_dwordx4 v8, s[64:67], s15 offen lds
    s_add_u32 s14, s41, s40
    s_add_u32 m0, s42, 50176
    s_add_u32 s15, s14, 4096
    buffer_load_dwordx4 v9, s[64:67], s15 offen lds
    v_lshlrev_b32 v70, 16, v79
    v_and_b32 v71, 0xffff0000, v79
    v_lshlrev_b32 v72, 16, v87
    v_and_b32 v73, 0xffff0000, v87
    v_mul_f32 v70, v70, v72
    v_mul_f32 v71, v71, v73
    v_cvt_pk_bf16_f32 v70, v70, v71
    v_lshlrev_b32 v71, 16, v70
    v_and_b32 v70, 0xffff0000, v70
    ds_read_b128 v[124:127], v19 offset:16384
    ds_read_b128 v[128:131], v19 offset:24576
    s_waitcnt lgkmcnt(4)
    v_mfma_f32_32x32x16_bf16 v[92:107], v[168:171], v[132:135], v[92:107]
    v_mfma_f32_32x32x16_bf16 v[108:123], v[168:171], v[136:139], v[108:123]
    s_add_u32 s14, s41, s40
    s_add_u32 m0, s42, 51200
    s_add_u32 s15, s14, 8192
    buffer_load_dwordx4 v10, s[64:67], s15 offen lds
    s_add_u32 s14, s41, s40
    s_add_u32 m0, s42, 52224
    s_add_u32 s15, s14, 12288
    buffer_load_dwordx4 v11, s[64:67], s15 offen lds
    v_add_f32 v50, v50, v71
    v_add_f32 v50, v50, v70
    v_lshlrev_b32 v70, 16, v80
    v_and_b32 v71, 0xffff0000, v80
    v_lshlrev_b32 v72, 16, v88
    v_and_b32 v73, 0xffff0000, v88
    v_mul_f32 v70, v70, v72
    v_mul_f32 v71, v71, v73
    v_cvt_pk_bf16_f32 v70, v70, v71
    ds_read_b128 v[132:135], v20 offset:16384
    ds_read_b128 v[136:139], v20 offset:24576
    s_waitcnt lgkmcnt(4)
    v_mfma_f32_32x32x16_bf16 v[92:107], v[172:175], v[140:143], v[92:107]
    v_mfma_f32_32x32x16_bf16 v[108:123], v[172:175], v[144:147], v[108:123]
    s_add_u32 s14, s36, s40
    s_add_u32 m0, s43, 8192
    s_add_u32 s15, s14, 0
    buffer_load_dwordx4 v12, s[60:63], s15 offen lds
    s_add_u32 s14, s36, s40
    s_add_u32 m0, s43, 9216
    s_add_u32 s15, s14, 16384
    buffer_load_dwordx4 v13, s[60:63], s15 offen lds
    v_lshlrev_b32 v71, 16, v70
    v_and_b32 v70, 0xffff0000, v70
    v_add_f32 v50, v50, v71
    v_add_f32 v50, v50, v70
    v_lshlrev_b32 v70, 16, v81
    v_and_b32 v71, 0xffff0000, v81
    v_lshlrev_b32 v72, 16, v89
    v_and_b32 v73, 0xffff0000, v89
    ds_read_b128 v[140:143], v21 offset:16384
    ds_read_b128 v[144:147], v21 offset:24576
    s_waitcnt lgkmcnt(4)
    v_mfma_f32_32x32x16_bf16 v[92:107], v[176:179], v[124:127], v[92:107]
    v_mfma_f32_32x32x16_bf16 v[108:123], v[176:179], v[128:131], v[108:123]
    s_add_u32 s14, s36, s40
    s_add_u32 m0, s43, 10240
    s_add_u32 s15, s14, 2048
    buffer_load_dwordx4 v14, s[60:63], s15 offen lds
    s_add_u32 s14, s36, s40
    s_add_u32 m0, s43, 11264
    s_add_u32 s15, s14, 18432
    buffer_load_dwordx4 v15, s[60:63], s15 offen lds
    v_mul_f32 v70, v70, v72
    v_mul_f32 v71, v71, v73
    v_cvt_pk_bf16_f32 v70, v70, v71
    v_lshlrev_b32 v71, 16, v70
    v_and_b32 v70, 0xffff0000, v70
    v_add_f32 v50, v50, v71
    v_add_f32 v50, v50, v70
    v_lshlrev_b32 v70, 16, v82
    v_and_b32 v71, 0xffff0000, v82
    ds_read_b128 v[124:127], v22 offset:16384
    ds_read_b128 v[128:131], v22 offset:24576
    s_waitcnt lgkmcnt(4)
    v_mfma_f32_32x32x16_bf16 v[92:107], v[180:183], v[132:135], v[92:107]
    v_mfma_f32_32x32x16_bf16 v[108:123], v[180:183], v[136:139], v[108:123]
    s_add_u32 s14, s36, s40
    s_add_u32 m0, s43, 12288
    s_add_u32 s15, s14, 4096
    buffer_load_dwordx4 v12, s[60:63], s15 offen lds
    v_lshlrev_b32 v72, 16, v90
    v_and_b32 v73, 0xffff0000, v90
    v_mul_f32 v70, v70, v72
    v_mul_f32 v71, v71, v73
    v_cvt_pk_bf16_f32 v70, v70, v71
    v_lshlrev_b32 v71, 16, v70
    v_and_b32 v70, 0xffff0000, v70
    v_add_f32 v50, v50, v71
    v_add_f32 v50, v50, v70
    ds_read_b128 v[132:135], v23 offset:16384
    ds_read_b128 v[136:139], v23 offset:24576
    s_waitcnt lgkmcnt(4)
    v_mfma_f32_32x32x16_bf16 v[92:107], v[184:187], v[140:143], v[92:107]
    v_mfma_f32_32x32x16_bf16 v[108:123], v[184:187], v[144:147], v[108:123]
    s_add_u32 s14, s36, s40
    s_add_u32 m0, s43, 13312
    s_add_u32 s15, s14, 20480
    buffer_load_dwordx4 v13, s[60:63], s15 offen lds
    v_lshlrev_b32 v70, 16, v83
    v_and_b32 v71, 0xffff0000, v83
    v_lshlrev_b32 v72, 16, v91
    v_and_b32 v73, 0xffff0000, v91
    v_mul_f32 v70, v70, v72
    v_mul_f32 v71, v71, v73
    v_cvt_pk_bf16_f32 v70, v70, v71
    v_lshlrev_b32 v71, 16, v70
    v_and_b32 v70, 0xffff0000, v70
    s_waitcnt lgkmcnt(2)
    v_mfma_f32_32x32x16_bf16 v[92:107], v[188:191], v[124:127], v[92:107]
    v_mfma_f32_32x32x16_bf16 v[108:123], v[188:191], v[128:131], v[108:123]
    s_add_u32 s14, s36, s40
    s_add_u32 m0, s43, 14336
    s_add_u32 s15, s14, 6144
    buffer_load_dwordx4 v14, s[60:63], s15 offen lds
    v_add_f32 v50, v50, v71
    v_add_f32 v50, v50, v70
    s_nop 1
    v_add_f32_dpp v50, v50, v50 row_ror:1 row_mask:0xf bank_mask:0xf
    s_nop 1
    v_add_f32_dpp v50, v50, v50 row_ror:2 row_mask:0xf bank_mask:0xf
    s_nop 1
    v_add_f32_dpp v50, v50, v50 row_ror:4 row_mask:0xf bank_mask:0xf
    s_nop 1
    v_add_f32_dpp v50, v50, v50 row_ror:8 row_mask:0xf bank_mask:0xf
    v_mov_b32 v70, v50
    s_nop 1
    v_permlane16_swap_b32 v70, v50
    s_waitcnt lgkmcnt(0)
    v_mfma_f32_32x32x16_bf16 v[92:107], v[192:195], v[132:135], v[92:107]
    v_mfma_f32_32x32x16_bf16 v[108:123], v[192:195], v[136:139], v[108:123]
    s_add_u32 s14, s36, s40
    s_add_u32 m0, s43, 15360
    s_add_u32 s15, s14, 22528
    buffer_load_dwordx4 v15, s[60:63], s15 offen lds
    v_add_f32 v50, v50, v70
    v_cvt_pk_bf16_f32 v50, v50, v50
    v_lshlrev_b32 v50, 16, v50
    v_mul_f32 v50, 0xbfb8aa3b, v50
    v_exp_f32 v50, v50
    s_nop 0
    v_add_f32 v50, 1.0, v50
    v_rcp_f32 v50, v50
    s_nop 0
    v_cvt_pk_bf16_f32 v50, v50, v50
    s_mov_b64 exec, 1
    global_load_dword v43, v42, s[56:57] sc1
    s_mov_b64 exec, -1
    buffer_load_dword v218, v218, s[68:71], s45 offen
    s_waitcnt vmcnt(14)
    v_mov_b32 v32, 3
    ds_write_b32 v41, v32
    ds_read_b128 v[164:167], v24 offset:0
    ds_read_b128 v[168:171], v25 offset:0
    ds_read_b128 v[172:175], v26 offset:0
    ds_read_b128 v[176:179], v27 offset:0
    ds_read_b128 v[180:183], v28 offset:0
    ds_read_b128 v[184:187], v29 offset:0
    ds_read_b128 v[188:191], v30 offset:0
    ds_read_b128 v[192:195], v31 offset:0
    s_mov_b32 s11, 1048576
gated_mix__ssm_conv_s5__ssm_conv_s4__prompt_kernel_SW8:
    ds_read_b128 v[32:35], v40 offset:0
    ds_read_b128 v[124:127], v16 offset:32768
    ds_read_b128 v[128:131], v16 offset:40960
    ds_read_b128 v[132:135], v17 offset:32768
    ds_read_b128 v[136:139], v17 offset:40960
    s_waitcnt lgkmcnt(4)
    v_min3_u32 v32, v32, v33, v34
    v_min_u32 v32, v32, v35
    s_sub_u32 s11, s11, 1
    v_readfirstlane_b32 s14, v32
    s_cmp_eq_u32 s11, 0
    s_cbranch_scc1 gated_mix__ssm_conv_s5__ssm_conv_s4__prompt_kernel_SD9
    s_cmp_lt_u32 s14, 3
    s_cbranch_scc1 gated_mix__ssm_conv_s5__ssm_conv_s4__prompt_kernel_SW8
gated_mix__ssm_conv_s5__ssm_conv_s4__prompt_kernel_SD9:
    ds_read_b128 v[140:143], v18 offset:32768
    ds_read_b128 v[144:147], v18 offset:40960
    s_waitcnt lgkmcnt(4)
    v_mfma_f32_32x32x16_bf16 v[92:107], v[164:167], v[124:127], v[92:107]
    v_mfma_f32_32x32x16_bf16 v[108:123], v[164:167], v[128:131], v[108:123]
    s_add_u32 m0, s23, 0
    s_add_u32 s15, s22, 0
    buffer_load_dwordx4 v8, s[68:71], s15 offen lds
    s_add_u32 m0, s23, 1024
    s_add_u32 s15, s22, 4096
    buffer_load_dwordx4 v9, s[68:71], s15 offen lds
    v_lshlrev_b32 v5, 16, v50
    v_lshlrev_b32 v4, 16, v50
    s_nop 1
    v_permlane32_swap_b32 v4, v5
    v_lshrrev_b32 v73, 5, v1
    s_lshl_b32 s47, s3, 2
    s_sub_u32 s46, s6, 1
    ds_read_b128 v[124:127], v19 offset:32768
    ds_read_b128 v[128:131], v19 offset:40960
    s_waitcnt lgkmcnt(4)
    v_mfma_f32_32x32x16_bf16 v[92:107], v[168:171], v[132:135], v[92:107]
    v_mfma_f32_32x32x16_bf16 v[108:123], v[168:171], v[136:139], v[108:123]
    s_add_u32 m0, s23, 2048
    s_add_u32 s15, s22, 8192
    buffer_load_dwordx4 v10, s[68:71], s15 offen lds
    s_add_u32 m0, s23, 3072
    s_add_u32 s15, s22, 12288
    buffer_load_dwordx4 v11, s[68:71], s15 offen lds
    s_sub_u32 s46, s46, s47
    v_sub_u32 v73, s46, v73
    v_subrev_u32 v74, 0, v73
    v_cmp_le_i32 s[18:19], 0, v74
    v_max_i32 v74, 0, v74
    v_cvt_f32_i32 v72, v74
    ds_read_b128 v[132:135], v20 offset:32768
    ds_read_b128 v[136:139], v20 offset:40960
    s_waitcnt lgkmcnt(4)
    v_mfma_f32_32x32x16_bf16 v[92:107], v[172:175], v[140:143], v[92:107]
    v_mfma_f32_32x32x16_bf16 v[108:123], v[172:175], v[144:147], v[108:123]
    s_add_u32 m0, s23, 4096
    s_add_u32 s15, s22, 16384
    buffer_load_dwordx4 v8, s[68:71], s15 offen lds
    s_add_u32 m0, s23, 5120
    s_add_u32 s15, s22, 20480
    buffer_load_dwordx4 v9, s[68:71], s15 offen lds
    v_mul_f32 v72, 0x43000000, v72
    v_mul_f32 v70, v72, v47
    v_mul_f32 v71, v72, v48
    v_exp_f32 v70, v70
    v_fract_f32 v71, v71
    v_cos_f32 v212, v71
    ds_read_b128 v[140:143], v21 offset:32768
    ds_read_b128 v[144:147], v21 offset:40960
    s_waitcnt lgkmcnt(4)
    v_mfma_f32_32x32x16_bf16 v[92:107], v[176:179], v[124:127], v[92:107]
    v_mfma_f32_32x32x16_bf16 v[108:123], v[176:179], v[128:131], v[108:123]
    s_add_u32 m0, s23, 6144
    s_add_u32 s15, s22, 24576
    buffer_load_dwordx4 v10, s[68:71], s15 offen lds
    s_add_u32 m0, s23, 7168
    s_add_u32 s15, s22, 28672
    buffer_load_dwordx4 v11, s[68:71], s15 offen lds
    v_sin_f32 v213, v71
    v_mul_f32 v212, v212, v70
    v_mul_f32 v213, v213, v70
    v_subrev_u32 v74, 2, v73
    v_cmp_le_i32 s[20:21], 0, v74
    v_max_i32 v74, 0, v74
    ds_read_b128 v[124:127], v22 offset:32768
    ds_read_b128 v[128:131], v22 offset:40960
    s_waitcnt lgkmcnt(4)
    v_mfma_f32_32x32x16_bf16 v[92:107], v[180:183], v[132:135], v[92:107]
    v_mfma_f32_32x32x16_bf16 v[108:123], v[180:183], v[136:139], v[108:123]
    s_add_u32 m0, s43, 0
    s_add_u32 s15, s24, 512
    buffer_load_dwordx4 v8, s[68:71], s15 offen lds
    s_add_u32 m0, s43, 1024
    s_add_u32 s15, s24, 4608
    buffer_load_dwordx4 v9, s[68:71], s15 offen lds
    v_cvt_f32_i32 v72, v74
    v_mul_f32 v72, 0x43000000, v72
    v_mul_f32 v70, v72, v47
    v_mul_f32 v71, v72, v48
    v_exp_f32 v70, v70
    v_fract_f32 v71, v71
    ds_read_b128 v[132:135], v23 offset:32768
    ds_read_b128 v[136:139], v23 offset:40960
    s_waitcnt lgkmcnt(4)
    v_mfma_f32_32x32x16_bf16 v[92:107], v[184:187], v[140:143], v[92:107]
    v_mfma_f32_32x32x16_bf16 v[108:123], v[184:187], v[144:147], v[108:123]
    s_add_u32 m0, s43, 2048
    s_add_u32 s15, s24, 8704
    buffer_load_dwordx4 v10, s[68:71], s15 offen lds
    s_add_u32 m0, s43, 3072
    s_add_u32 s15, s24, 12800
    buffer_load_dwordx4 v11, s[68:71], s15 offen lds
    v_cos_f32 v214, v71
    v_sin_f32 v215, v71
    v_mul_f32 v214, v214, v70
    v_mul_f32 v215, v215, v70
    s_waitcnt lgkmcnt(2)
    v_mfma_f32_32x32x16_bf16 v[92:107], v[188:191], v[124:127], v[92:107]
    v_mfma_f32_32x32x16_bf16 v[108:123], v[188:191], v[128:131], v[108:123]
    s_add_u32 m0, s43, 4096
    s_add_u32 s15, s24, 16896
    buffer_load_dwordx4 v8, s[68:71], s15 offen lds
    s_add_u32 m0, s43, 5120
    s_add_u32 s15, s24, 20992
    buffer_load_dwordx4 v9, s[68:71], s15 offen lds
    s_waitcnt lgkmcnt(0)
    v_mfma_f32_32x32x16_bf16 v[92:107], v[192:195], v[132:135], v[92:107]
    v_mfma_f32_32x32x16_bf16 v[108:123], v[192:195], v[136:139], v[108:123]
    s_add_u32 m0, s43, 6144
    s_add_u32 s15, s24, 25088
    buffer_load_dwordx4 v10, s[68:71], s15 offen lds
    s_add_u32 m0, s43, 7168
    s_add_u32 s15, s24, 29184
    buffer_load_dwordx4 v11, s[68:71], s15 offen lds
    global_load_dword v221, v221, s[58:59]
    s_waitcnt vmcnt(19)
    v_mov_b32 v32, 4
    ds_write_b32 v41, v32
    ds_read_b128 v[164:167], v24 offset:8192
    ds_read_b128 v[168:171], v25 offset:8192
    ds_read_b128 v[172:175], v26 offset:8192
    ds_read_b128 v[176:179], v27 offset:8192
    ds_read_b128 v[180:183], v28 offset:8192
    ds_read_b128 v[184:187], v29 offset:8192
    ds_read_b128 v[188:191], v30 offset:8192
    ds_read_b128 v[192:195], v31 offset:8192
    s_mov_b32 s11, 1048576
gated_mix__ssm_conv_s5__ssm_conv_s4__prompt_kernel_SW10:
    ds_read_b128 v[32:35], v40 offset:0
    ds_read_b128 v[124:127], v16 offset:49152
    ds_read_b128 v[128:131], v16 offset:57344
    ds_read_b128 v[132:135], v17 offset:49152
    ds_read_b128 v[136:139], v17 offset:57344
    s_waitcnt lgkmcnt(4)
    v_min3_u32 v32, v32, v33, v34
    v_min_u32 v32, v32, v35
    s_sub_u32 s11, s11, 1
    v_readfirstlane_b32 s14, v32
    s_cmp_eq_u32 s11, 0
    s_cbranch_scc1 gated_mix__ssm_conv_s5__ssm_conv_s4__prompt_kernel_SD11
    s_cmp_lt_u32 s14, 4
    s_cbranch_scc1 gated_mix__ssm_conv_s5__ssm_conv_s4__prompt_kernel_SW10
gated_mix__ssm_conv_s5__ssm_conv_s4__prompt_kernel_SD11:
    ds_read_b128 v[140:143], v18 offset:49152
    ds_read_b128 v[144:147], v18 offset:57344
    s_waitcnt lgkmcnt(4)
    v_mfma_f32_32x32x16_bf16 v[92:107], v[164:167], v[124:127], v[92:107]
    v_mfma_f32_32x32x16_bf16 v[108:123], v[164:167], v[128:131], v[108:123]
    s_add_u32 m0, s44, 32768
    s_add_u32 s15, s25, 256
    buffer_load_dwordx4 v8, s[72:75], s15 offen lds
    s_add_u32 m0, s44, 33792
    s_add_u32 s15, s25, 4352
    buffer_load_dwordx4 v9, s[72:75], s15 offen lds
    ds_read_b128 v[124:127], v19 offset:49152
    ds_read_b128 v[128:131], v19 offset:57344
    s_waitcnt lgkmcnt(4)
    v_mfma_f32_32x32x16_bf16 v[92:107], v[168:171], v[132:135], v[92:107]
    v_mfma_f32_32x32x16_bf16 v[108:123], v[168:171], v[136:139], v[108:123]
    s_add_u32 m0, s44, 34816
    s_add_u32 s15, s25, 8448
    buffer_load_dwordx4 v10, s[72:75], s15 offen lds
    s_add_u32 m0, s44, 35840
    s_add_u32 s15, s25, 12544
    buffer_load_dwordx4 v11, s[72:75], s15 offen lds
    ds_read_b128 v[132:135], v20 offset:49152
    ds_read_b128 v[136:139], v20 offset:57344
    s_waitcnt lgkmcnt(4)
    v_mfma_f32_32x32x16_bf16 v[92:107], v[172:175], v[140:143], v[92:107]
    v_mfma_f32_32x32x16_bf16 v[108:123], v[172:175], v[144:147], v[108:123]
    s_add_u32 m0, s43, 8192
    s_add_u32 s15, s24, 33280
    buffer_load_dwordx4 v8, s[68:71], s15 offen lds
    s_add_u32 m0, s43, 9216
    s_add_u32 s15, s24, 37376
    buffer_load_dwordx4 v9, s[68:71], s15 offen lds
    ds_read_b128 v[140:143], v21 offset:49152
    ds_read_b128 v[144:147], v21 offset:57344
    s_waitcnt lgkmcnt(4)
    v_mfma_f32_32x32x16_bf16 v[92:107], v[176:179], v[124:127], v[92:107]
    v_mfma_f32_32x32x16_bf16 v[108:123], v[176:179], v[128:131], v[108:123]
    s_add_u32 m0, s43, 10240
    s_add_u32 s15, s24, 41472
    buffer_load_dwordx4 v10, s[68:71], s15 offen lds
    s_add_u32 m0, s43, 11264
    s_add_u32 s15, s24, 45568
    buffer_load_dwordx4 v11, s[68:71], s15 offen lds
    ds_read_b128 v[124:127], v22 offset:49152
    ds_read_b128 v[128:131], v22 offset:57344
    s_waitcnt lgkmcnt(4)
    v_mfma_f32_32x32x16_bf16 v[92:107], v[180:183], v[132:135], v[92:107]
    v_mfma_f32_32x32x16_bf16 v[108:123], v[180:183], v[136:139], v[108:123]
    s_add_u32 m0, s43, 12288
    s_add_u32 s15, s24, 49664
    buffer_load_dwordx4 v8, s[68:71], s15 offen lds
    ds_read_b128 v[132:135], v23 offset:49152
    ds_read_b128 v[136:139], v23 offset:57344
    s_waitcnt lgkmcnt(4)
    v_mfma_f32_32x32x16_bf16 v[92:107], v[184:187], v[140:143], v[92:107]
    v_mfma_f32_32x32x16_bf16 v[108:123], v[184:187], v[144:147], v[108:123]
    s_add_u32 m0, s43, 13312
    s_add_u32 s15, s24, 53760
    buffer_load_dwordx4 v9, s[68:71], s15 offen lds
    s_waitcnt lgkmcnt(2)
    v_mfma_f32_32x32x16_bf16 v[92:107], v[188:191], v[124:127], v[92:107]
    v_mfma_f32_32x32x16_bf16 v[108:123], v[188:191], v[128:131], v[108:123]
    s_add_u32 m0, s43, 14336
    s_add_u32 s15, s24, 57856
    buffer_load_dwordx4 v10, s[68:71], s15 offen lds
    s_waitcnt lgkmcnt(0)
    v_mfma_f32_32x32x16_bf16 v[92:107], v[192:195], v[132:135], v[92:107]
    v_mfma_f32_32x32x16_bf16 v[108:123], v[192:195], v[136:139], v[108:123]
    s_nop 7
    s_nop 2
    v_fmac_f32 v94, v52, v92
    v_fmac_f32 v95, v52, v93
    v_fmac_f32 v110, v52, v108
    v_fmac_f32 v111, v52, v109
    v_fma_f32 v94, -v53, v108, v94
    v_fma_f32 v95, -v53, v109, v95
    v_fmac_f32 v110, v53, v92
    v_fmac_f32 v111, v53, v93
    v_fmac_f32 v96, v52, v94
    v_fmac_f32 v97, v52, v95
    v_fmac_f32 v112, v52, v110
    v_fmac_f32 v113, v52, v111
    v_fma_f32 v96, -v53, v110, v96
    v_fma_f32 v97, -v53, v111, v97
    v_fmac_f32 v112, v53, v94
    v_fmac_f32 v113, v53, v95
    v_fmac_f32 v98, v52, v96
    v_fmac_f32 v99, v52, v97
    v_fmac_f32 v114, v52, v112
    v_fmac_f32 v115, v52, v113
    v_fma_f32 v98, -v53, v112, v98
    v_fma_f32 v99, -v53, v113, v99
    v_fmac_f32 v114, v53, v96
    v_fmac_f32 v115, v53, v97
    v_fmac_f32 v100, v52, v98
    v_fmac_f32 v101, v52, v99
    v_fmac_f32 v116, v52, v114
    v_fmac_f32 v117, v52, v115
    v_fma_f32 v100, -v53, v114, v100
    v_fma_f32 v101, -v53, v115, v101
    v_fmac_f32 v116, v53, v98
    v_fmac_f32 v117, v53, v99
    v_fmac_f32 v102, v52, v100
    v_fmac_f32 v103, v52, v101
    v_fmac_f32 v118, v52, v116
    v_fmac_f32 v119, v52, v117
    v_fma_f32 v102, -v53, v116, v102
    v_fma_f32 v103, -v53, v117, v103
    v_fmac_f32 v118, v53, v100
    v_fmac_f32 v119, v53, v101
    v_fmac_f32 v104, v52, v102
    v_fmac_f32 v105, v52, v103
    v_fmac_f32 v120, v52, v118
    v_fmac_f32 v121, v52, v119
    v_fma_f32 v104, -v53, v118, v104
    v_fma_f32 v105, -v53, v119, v105
    v_fmac_f32 v120, v53, v102
    v_fmac_f32 v121, v53, v103
    v_fmac_f32 v106, v52, v104
    v_fmac_f32 v107, v52, v105
    v_fmac_f32 v122, v52, v120
    v_fmac_f32 v123, v52, v121
    v_fma_f32 v106, -v53, v120, v106
    v_fma_f32 v107, -v53, v121, v107
    v_fmac_f32 v122, v53, v104
    v_fmac_f32 v123, v53, v105
    v_mov_b32 v32, v107
    v_mov_b32 v33, v123
    v_lshlrev_b32 v34, 3, v1
    v_add_u32 v35, s43, v34
    v_fmac_f32 v32, v54, v106
    v_fmac_f32 v33, v54, v122
    v_fma_f32 v32, -v55, v122, v32
    v_fmac_f32 v33, v55, v106
    ds_write_b64 v35, v[32:33] offset:15360
    v_mov_b32 v36, 5
    ds_write_b32 v41, v36
    v_and_b32 v37, 0xf8, v34
    v_add_u32 v37, 80896, v37
    v_mov_b32 v61, v106
    v_mov_b32 v63, v122
    v_mov_b32 v60, 0
    v_mov_b32 v62, 0
    s_waitcnt vmcnt(29)
    v_readfirstlane_b32 s10, v43
    s_cmp_lg_u32 s10, 0
    s_cbranch_scc1 gated_mix__ssm_conv_s5__ssm_conv_s4__prompt_kernel_TD13
    s_mov_b32 s11, 1048576
gated_mix__ssm_conv_s5__ssm_conv_s4__prompt_kernel_TG12:
    global_load_dword v43, v42, s[56:57] sc1
    s_waitcnt vmcnt(0)
    v_readfirstlane_b32 s10, v43
    s_sub_u32 s11, s11, 1
    s_cmp_eq_u32 s11, 0
    s_cbranch_scc1 gated_mix__ssm_conv_s5__ssm_conv_s4__prompt_kernel_TD13
    s_cmp_eq_u32 s10, 0
    s_cbranch_scc1 gated_mix__ssm_conv_s5__ssm_conv_s4__prompt_kernel_TG12
gated_mix__ssm_conv_s5__ssm_conv_s4__prompt_kernel_TD13:
    v_mov_b32 v6, s10
    v_mov_b32 v7, s10
    v_mov_b32 v164, s10
    v_mov_b32 v165, s10
    s_mov_b32 s11, 1048576
gated_mix__ssm_conv_s5__ssm_conv_s4__prompt_kernel_SW14:
    ds_read_b128 v[32:35], v40 offset:0
    ds_read_b64 v[148:149], v37 offset:0
    ds_read_b64 v[150:151], v37 offset:256
    ds_read_b64 v[152:153], v37 offset:16384
    ds_read_b64 v[154:155], v37 offset:16640
    ds_read_b64 v[156:157], v37 offset:32768
    ds_read_b64 v[158:159], v37 offset:33024
    ds_read_b64 v[160:161], v37 offset:49152
    ds_read_b64 v[162:163], v37 offset:49408
    s_waitcnt lgkmcnt(8)
    v_min3_u32 v32, v32, v33, v34
    v_min_u32 v32, v32, v35
    s_sub_u32 s11, s11, 1
    v_readfirstlane_b32 s14, v32
    s_cmp_eq_u32 s11, 0
    s_cbranch_scc1 gated_mix__ssm_conv_s5__ssm_conv_s4__prompt_kernel_SD15
    s_cmp_lt_u32 s14, 5
    s_cbranch_scc1 gated_mix__ssm_conv_s5__ssm_conv_s4__prompt_kernel_SW14
gated_mix__ssm_conv_s5__ssm_conv_s4__prompt_kernel_SD15:
    s_waitcnt lgkmcnt(6)
    v_fmac_f32 v150, v56, v148
    v_fmac_f32 v151, v56, v149
    v_fma_f32 v150, -v57, v149, v150
    v_fmac_f32 v151, v57, v148
    s_waitcnt lgkmcnt(5)
    v_fmac_f32 v152, v56, v150
    v_fmac_f32 v153, v56, v151
    v_fma_f32 v152, -v57, v151, v152
    v_fmac_f32 v153, v57, v150
    s_waitcnt lgkmcnt(4)
    v_fmac_f32 v154, v56, v152
    v_fmac_f32 v155, v56, v153
    v_fma_f32 v154, -v57, v153, v154
    v_fmac_f32 v155, v57, v152
    s_waitcnt lgkmcnt(3)
    v_fmac_f32 v156, v56, v154
    v_fmac_f32 v157, v56, v155
    v_fma_f32 v156, -v57, v155, v156
    v_fmac_f32 v157, v57, v154
    s_waitcnt lgkmcnt(2)
    v_fmac_f32 v158, v56, v156
    v_fmac_f32 v159, v56, v157
    v_fma_f32 v158, -v57, v157, v158
    v_fmac_f32 v159, v57, v156
    s_waitcnt lgkmcnt(1)
    v_fmac_f32 v160, v56, v158
    v_fmac_f32 v161, v56, v159
    v_fma_f32 v160, -v57, v159, v160
    v_fmac_f32 v161, v57, v158
    s_waitcnt lgkmcnt(0)
    v_fmac_f32 v162, v56, v160
    v_fmac_f32 v163, v56, v161
    v_fma_f32 v162, -v57, v161, v162
    v_fmac_f32 v163, v57, v160
    s_cmp_lg_u32 s3, 0
    s_cbranch_scc1 gated_mix__ssm_conv_s5__ssm_conv_s4__prompt_kernel_NE16
    s_mov_b64 exec, 0xffffffff
    global_store_dwordx4 v217, v[162:165], s[58:59] sc1
    s_mov_b64 exec, -1
gated_mix__ssm_conv_s5__ssm_conv_s4__prompt_kernel_NE16:
    v_mov_b32 v36, 6
    ds_write_b32 v41, v36
    s_mov_b64 exec, 2
    global_load_dword v43, v42, s[56:57] sc1
    s_mov_b64 exec, -1
    v_cmp_eq_u32 vcc, 1, v49
    s_nop 1
    v_cndmask_b32 v60, v60, v148, vcc
    v_cndmask_b32 v62, v62, v149, vcc
    v_cmp_eq_u32 vcc, 2, v49
    s_nop 1
    v_cndmask_b32 v60, v60, v150, vcc
    v_cndmask_b32 v62, v62, v151, vcc
    v_cmp_eq_u32 vcc, 3, v49
    s_nop 1
    v_cndmask_b32 v60, v60, v152, vcc
    v_cndmask_b32 v62, v62, v153, vcc
    v_cmp_eq_u32 vcc, 4, v49
    s_nop 1
    v_cndmask_b32 v60, v60, v154, vcc
    v_cndmask_b32 v62, v62, v155, vcc
    v_cmp_eq_u32 vcc, 5, v49
    s_nop 1
    v_cndmask_b32 v60, v60, v156, vcc
    v_cndmask_b32 v62, v62, v157, vcc
    v_cmp_eq_u32 vcc, 6, v49
    s_nop 1
    v_cndmask_b32 v60, v60, v158, vcc
    v_cndmask_b32 v62, v62, v159, vcc
    v_cmp_eq_u32 vcc, 7, v49
    s_nop 1
    v_cndmask_b32 v60, v60, v160, vcc
    v_cndmask_b32 v62, v62, v161, vcc
    v_fmac_f32 v61, v54, v60
    v_fmac_f32 v63, v54, v62
    v_fma_f32 v61, -v55, v62, v61
    v_fmac_f32 v63, v55, v60
    v_mul_f32 v32, v59, v108
    v_mul_f32 v33, v59, v109
    v_mul_f32 v108, v58, v108
    v_mul_f32 v109, v58, v109
    v_fmac_f32 v108, v59, v92
    v_fmac_f32 v109, v59, v93
    v_fma_f32 v92, v58, v92, -v32
    v_fma_f32 v93, v58, v93, -v33
    v_mul_f32 v34, v59, v110
    v_mul_f32 v35, v59, v111
    v_mul_f32 v110, v58, v110
    v_mul_f32 v111, v58, v111
    v_fmac_f32 v110, v59, v94
    v_fmac_f32 v111, v59, v95
    v_fma_f32 v94, v58, v94, -v34
    v_fma_f32 v95, v58, v95, -v35
    v_mul_f32 v32, v59, v112
    v_mul_f32 v33, v59, v113
    v_mul_f32 v112, v58, v112
    v_mul_f32 v113, v58, v113
    v_fmac_f32 v112, v59, v96
    v_fmac_f32 v113, v59, v97
    v_fma_f32 v96, v58, v96, -v32
    v_fma_f32 v97, v58, v97, -v33
    v_mul_f32 v34, v59, v114
    v_mul_f32 v35, v59, v115
    v_mul_f32 v114, v58, v114
    v_mul_f32 v115, v58, v115
    v_fmac_f32 v114, v59, v98
    v_fmac_f32 v115, v59, v99
    v_fma_f32 v98, v58, v98, -v34
    v_fma_f32 v99, v58, v99, -v35
    v_mul_f32 v32, v59, v116
    v_mul_f32 v33, v59, v117
    v_mul_f32 v116, v58, v116
    v_mul_f32 v117, v58, v117
    v_fmac_f32 v116, v59, v100
    v_fmac_f32 v117, v59, v101
    v_fma_f32 v100, v58, v100, -v32
    v_fma_f32 v101, v58, v101, -v33
    v_mul_f32 v34, v59, v118
    v_mul_f32 v35, v59, v119
    v_mul_f32 v118, v58, v118
    v_mul_f32 v119, v58, v119
    v_fmac_f32 v118, v59, v102
    v_fmac_f32 v119, v59, v103
    v_fma_f32 v102, v58, v102, -v34
    v_fma_f32 v103, v58, v103, -v35
    v_mul_f32 v32, v59, v120
    v_mul_f32 v33, v59, v121
    v_mul_f32 v120, v58, v120
    v_mul_f32 v121, v58, v121
    v_fmac_f32 v120, v59, v104
    v_fmac_f32 v121, v59, v105
    v_fma_f32 v104, v58, v104, -v32
    v_fma_f32 v105, v58, v105, -v33
    v_mul_f32 v34, v59, v122
    v_mul_f32 v35, v59, v123
    v_mul_f32 v122, v58, v122
    v_mul_f32 v123, v58, v123
    v_fmac_f32 v122, v59, v106
    v_fmac_f32 v123, v59, v107
    v_fma_f32 v106, v58, v106, -v34
    v_fma_f32 v107, v58, v107, -v35
    s_lshl_b32 s43, s3, 12
    s_add_u32 s43, s43, 131072
    v_lshl_add_u32 v24, v1, 5, s43
    v_lshrrev_b32 v33, 4, v1
    v_and_b32 v34, 15, v1
    v_lshlrev_b32 v34, 3, v34
    v_lshl_add_u32 v25, v33, 8, v34
    v_add_u32 v25, s43, v25
    v_lshl_add_u32 v26, v1, 4, s34
    v_add_u32 v27, 32768, v26
    v_mov_b32 v68, 0
    v_mov_b32 v69, 0
    s_cmp_eq_u64 s[18:19], 0
    s_cbranch_scc1 gated_mix__ssm_conv_s5__ssm_conv_s4__prompt_kernel_GD18
    s_mov_b32 s11, 1048576
    s_mov_b64 s[12:13], s[18:19]
    s_mov_b64 s[14:15], s[20:21]
gated_mix__ssm_conv_s5__ssm_conv_s4__prompt_kernel_GE17:
    s_mov_b64 exec, s[12:13]
    global_load_dwordx3 v[168:170], v216, s[58:59] sc1
    s_mov_b64 exec, s[14:15]
    global_load_dwordx3 v[172:174], v216, s[58:59] offset:1024 sc1
    s_sub_u32 s11, s11, 1
    s_cmp_eq_u32 s11, 0
    s_waitcnt vmcnt(0)
    s_cbranch_scc1 gated_mix__ssm_conv_s5__ssm_conv_s4__prompt_kernel_GX19
    v_cmp_ne_u32 s[14:15], s10, v174
    s_mov_b64 exec, s[12:13]
    v_cmp_ne_u32 s[12:13], s10, v170
    s_or_b64 vcc, s[12:13], s[14:15]
    s_cbranch_scc1 gated_mix__ssm_conv_s5__ssm_conv_s4__prompt_kernel_GE17
gated_mix__ssm_conv_s5__ssm_conv_s4__prompt_kernel_GX19:
    s_mov_b64 exec, s[18:19]
    v_pk_fma_f32 v[68:69], v[212:213], v[168:169], v[68:69] op_sel:[0,0,0] op_sel_hi:[0,1,1]
    v_pk_fma_f32 v[68:69], v[212:213], v[168:169], v[68:69] op_sel:[1,1,0] op_sel_hi:[1,0,1] neg_lo:[1,0,0]
    s_mov_b64 exec, s[20:21]
    v_pk_fma_f32 v[68:69], v[214:215], v[172:173], v[68:69] op_sel:[0,0,0] op_sel_hi:[0,1,1]
    v_pk_fma_f32 v[68:69], v[214:215], v[172:173], v[68:69] op_sel:[1,1,0] op_sel_hi:[1,0,1] neg_lo:[1,0,0]
    s_mov_b64 exec, -1
    v_mov_b32 v32, v68
    v_mov_b32 v33, v69
    s_nop 0
    v_permlane32_swap_b32 v32, v68
    v_permlane32_swap_b32 v33, v69
    v_pk_add_f32 v[68:69], v[68:69], v[32:33]
gated_mix__ssm_conv_s5__ssm_conv_s4__prompt_kernel_GD18:
    s_waitcnt vmcnt(0)
    ds_write_b64 v219, v[68:69]
    v_readlane_b32 s1, v43, 1
    v_mov_b32 v36, 7
    ds_write_b32 v41, v36
    s_mov_b32 s11, 1048576
gated_mix__ssm_conv_s5__ssm_conv_s4__prompt_kernel_SW20:
    ds_read_b128 v[32:35], v40 offset:0
    ds_read2_b64 v[164:167], v220 offset1:32
    ds_read2_b64 v[168:171], v220 offset0:64 offset1:96
    s_waitcnt lgkmcnt(2)
    v_min3_u32 v32, v32, v33, v34
    v_min_u32 v32, v32, v35
    s_sub_u32 s11, s11, 1
    v_readfirstlane_b32 s14, v32
    s_cmp_eq_u32 s11, 0
    s_cbranch_scc1 gated_mix__ssm_conv_s5__ssm_conv_s4__prompt_kernel_SD21
    s_cmp_lt_u32 s14, 7
    s_cbranch_scc1 gated_mix__ssm_conv_s5__ssm_conv_s4__prompt_kernel_SW20
gated_mix__ssm_conv_s5__ssm_conv_s4__prompt_kernel_SD21:
    ds_read_b128 v[36:39], v40 offset:16
    s_waitcnt lgkmcnt(1)
    v_pk_add_f32 v[164:165], v[164:165], v[166:167]
    v_pk_add_f32 v[168:169], v[168:169], v[170:171]
    v_pk_add_f32 v[68:69], v[164:165], v[168:169]
    v_pk_fma_f32 v[60:61], v[68:69], v[64:65], v[60:61] op_sel:[0,0,0] op_sel_hi:[0,1,1]
    v_pk_fma_f32 v[62:63], v[68:69], v[66:67], v[62:63] op_sel:[0,0,0] op_sel_hi:[0,1,1]
    v_pk_fma_f32 v[60:61], v[68:69], v[66:67], v[60:61] op_sel:[1,0,0] op_sel_hi:[1,1,1] neg_lo:[1,0,0] neg_hi:[1,0,0]
    v_pk_fma_f32 v[62:63], v[68:69], v[64:65], v[62:63] op_sel:[1,0,0] op_sel_hi:[1,1,1]
    v_pk_fma_f32 v[92:93], v[196:197], v[60:61], v[92:93] op_sel:[0,0,0] op_sel_hi:[0,1,1]
    v_pk_fma_f32 v[108:109], v[196:197], v[62:63], v[108:109] op_sel:[0,0,0] op_sel_hi:[0,1,1]
    v_pk_fma_f32 v[92:93], v[196:197], v[62:63], v[92:93] op_sel:[1,0,0] op_sel_hi:[1,1,1] neg_lo:[1,0,0] neg_hi:[1,0,0]
    v_pk_fma_f32 v[108:109], v[196:197], v[60:61], v[108:109] op_sel:[1,0,0] op_sel_hi:[1,1,1]
    v_pk_fma_f32 v[94:95], v[198:199], v[60:61], v[94:95] op_sel:[0,0,0] op_sel_hi:[0,1,1]
    v_pk_fma_f32 v[110:111], v[198:199], v[62:63], v[110:111] op_sel:[0,0,0] op_sel_hi:[0,1,1]
    v_pk_fma_f32 v[94:95], v[198:199], v[62:63], v[94:95] op_sel:[1,0,0] op_sel_hi:[1,1,1] neg_lo:[1,0,0] neg_hi:[1,0,0]
    v_pk_fma_f32 v[110:111], v[198:199], v[60:61], v[110:111] op_sel:[1,0,0] op_sel_hi:[1,1,1]
    v_cvt_pk_bf16_f32 v164, v92, v93
    v_cvt_pk_bf16_f32 v172, -v108, -v109
    v_pk_fma_f32 v[96:97], v[200:201], v[60:61], v[96:97] op_sel:[0,0,0] op_sel_hi:[0,1,1]
    v_pk_fma_f32 v[112:113], v[200:201], v[62:63], v[112:113] op_sel:[0,0,0] op_sel_hi:[0,1,1]
    v_pk_fma_f32 v[96:97], v[200:201], v[62:63], v[96:97] op_sel:[1,0,0] op_sel_hi:[1,1,1] neg_lo:[1,0,0] neg_hi:[1,0,0]
    v_pk_fma_f32 v[112:113], v[200:201], v[60:61], v[112:113] op_sel:[1,0,0] op_sel_hi:[1,1,1]
    v_cvt_pk_bf16_f32 v165, v94, v95
    v_cvt_pk_bf16_f32 v173, -v110, -v111
    v_pk_fma_f32 v[98:99], v[202:203], v[60:61], v[98:99] op_sel:[0,0,0] op_sel_hi:[0,1,1]
    v_pk_fma_f32 v[114:115], v[202:203], v[62:63], v[114:115] op_sel:[0,0,0] op_sel_hi:[0,1,1]
    v_pk_fma_f32 v[98:99], v[202:203], v[62:63], v[98:99] op_sel:[1,0,0] op_sel_hi:[1,1,1] neg_lo:[1,0,0] neg_hi:[1,0,0]
    v_pk_fma_f32 v[114:115], v[202:203], v[60:61], v[114:115] op_sel:[1,0,0] op_sel_hi:[1,1,1]
    v_cvt_pk_bf16_f32 v166, v96, v97
    v_cvt_pk_bf16_f32 v174, -v112, -v113
    v_pk_fma_f32 v[100:101], v[204:205], v[60:61], v[100:101] op_sel:[0,0,0] op_sel_hi:[0,1,1]
    v_pk_fma_f32 v[116:117], v[204:205], v[62:63], v[116:117] op_sel:[0,0,0] op_sel_hi:[0,1,1]
    v_pk_fma_f32 v[100:101], v[204:205], v[62:63], v[100:101] op_sel:[1,0,0] op_sel_hi:[1,1,1] neg_lo:[1,0,0] neg_hi:[1,0,0]
    v_pk_fma_f32 v[116:117], v[204:205], v[60:61], v[116:117] op_sel:[1,0,0] op_sel_hi:[1,1,1]
    v_cvt_pk_bf16_f32 v167, v98, v99
    v_cvt_pk_bf16_f32 v175, -v114, -v115
    v_pk_fma_f32 v[102:103], v[206:207], v[60:61], v[102:103] op_sel:[0,0,0] op_sel_hi:[0,1,1]
    v_pk_fma_f32 v[118:119], v[206:207], v[62:63], v[118:119] op_sel:[0,0,0] op_sel_hi:[0,1,1]
    v_pk_fma_f32 v[102:103], v[206:207], v[62:63], v[102:103] op_sel:[1,0,0] op_sel_hi:[1,1,1] neg_lo:[1,0,0] neg_hi:[1,0,0]
    v_pk_fma_f32 v[118:119], v[206:207], v[60:61], v[118:119] op_sel:[1,0,0] op_sel_hi:[1,1,1]
    v_cvt_pk_bf16_f32 v168, v100, v101
    v_cvt_pk_bf16_f32 v176, -v116, -v117
    v_pk_fma_f32 v[104:105], v[208:209], v[60:61], v[104:105] op_sel:[0,0,0] op_sel_hi:[0,1,1]
    v_pk_fma_f32 v[120:121], v[208:209], v[62:63], v[120:121] op_sel:[0,0,0] op_sel_hi:[0,1,1]
    v_pk_fma_f32 v[104:105], v[208:209], v[62:63], v[104:105] op_sel:[1,0,0] op_sel_hi:[1,1,1] neg_lo:[1,0,0] neg_hi:[1,0,0]
    v_pk_fma_f32 v[120:121], v[208:209], v[60:61], v[120:121] op_sel:[1,0,0] op_sel_hi:[1,1,1]
    v_cvt_pk_bf16_f32 v169, v102, v103
    v_cvt_pk_bf16_f32 v177, -v118, -v119
    v_pk_fma_f32 v[106:107], v[210:211], v[60:61], v[106:107] op_sel:[0,0,0] op_sel_hi:[0,1,1]
    v_pk_fma_f32 v[122:123], v[210:211], v[62:63], v[122:123] op_sel:[0,0,0] op_sel_hi:[0,1,1]
    v_pk_fma_f32 v[106:107], v[210:211], v[62:63], v[106:107] op_sel:[1,0,0] op_sel_hi:[1,1,1] neg_lo:[1,0,0] neg_hi:[1,0,0]
    v_pk_fma_f32 v[122:123], v[210:211], v[60:61], v[122:123] op_sel:[1,0,0] op_sel_hi:[1,1,1]
    v_cvt_pk_bf16_f32 v170, v104, v105
    v_cvt_pk_bf16_f32 v178, -v120, -v121
    s_waitcnt lgkmcnt(0)
    v_min3_u32 v36, v36, v37, v38
    v_min_u32 v36, v36, v39
    v_cvt_pk_bf16_f32 v171, v106, v107
    v_readfirstlane_b32 s14, v36
    v_cvt_pk_bf16_f32 v179, -v122, -v123
    s_cmp_ge_u32 s14, 5
    s_cbranch_scc1 gated_mix__ssm_conv_s5__ssm_conv_s4__prompt_kernel_TF22
    s_mov_b32 s11, 1048576
gated_mix__ssm_conv_s5__ssm_conv_s4__prompt_kernel_PW23:
    ds_read_b128 v[36:39], v40 offset:16
    s_waitcnt lgkmcnt(0)
    v_min3_u32 v36, v36, v37, v38
    v_min_u32 v36, v36, v39
    s_sub_u32 s11, s11, 1
    v_readfirstlane_b32 s14, v36
    s_cmp_eq_u32 s11, 0
    s_cbranch_scc1 gated_mix__ssm_conv_s5__ssm_conv_s4__prompt_kernel_PD24
    s_cmp_lt_u32 s14, 5
    s_cbranch_scc1 gated_mix__ssm_conv_s5__ssm_conv_s4__prompt_kernel_PW23
gated_mix__ssm_conv_s5__ssm_conv_s4__prompt_kernel_PD24:
gated_mix__ssm_conv_s5__ssm_conv_s4__prompt_kernel_TF22:
    ds_write_b128 v24, v[164:167]
    ds_write_b128 v24, v[168:171] offset:16
    ds_write_b128 v24, v[172:175] offset:2048
    ds_write_b128 v24, v[176:179] offset:2064
    ds_read_b64_tr_b16 v[180:181], v25 offset:0
    ds_read_b64_tr_b16 v[182:183], v25 offset:128
    ds_read_b64_tr_b16 v[184:185], v25 offset:1024
    ds_read_b64_tr_b16 v[186:187], v25 offset:1152
    ds_read_b64_tr_b16 v[188:189], v25 offset:2048
    ds_read_b64_tr_b16 v[190:191], v25 offset:2176
    ds_read_b64_tr_b16 v[192:193], v25 offset:3072
    ds_read_b64_tr_b16 v[194:195], v25 offset:3200
    s_cmp_lg_u32 s0, s1
    s_cbranch_scc1 gated_mix__ssm_conv_s5__ssm_conv_s4__prompt_kernel_HS25
    s_waitcnt lgkmcnt(6)
    global_store_dwordx4 v26, v[180:183], s[58:59] offset:0
    s_waitcnt lgkmcnt(4)
    global_store_dwordx4 v27, v[184:187], s[58:59] offset:0
    s_waitcnt lgkmcnt(2)
    global_store_dwordx4 v26, v[188:191], s[58:59] offset:1024
    s_waitcnt lgkmcnt(0)
    global_store_dwordx4 v27, v[192:195], s[58:59] offset:1024
    s_branch gated_mix__ssm_conv_s5__ssm_conv_s4__prompt_kernel_P2
gated_mix__ssm_conv_s5__ssm_conv_s4__prompt_kernel_HS25:
    s_waitcnt lgkmcnt(6)
    global_store_dwordx4 v26, v[180:183], s[58:59] offset:0 sc1
    s_waitcnt lgkmcnt(4)
    global_store_dwordx4 v27, v[184:187], s[58:59] offset:0 sc1
    s_waitcnt lgkmcnt(2)
    global_store_dwordx4 v26, v[188:191], s[58:59] offset:1024 sc1
    s_waitcnt lgkmcnt(0)
    global_store_dwordx4 v27, v[192:195], s[58:59] offset:1024 sc1
    s_branch gated_mix__ssm_conv_s5__ssm_conv_s4__prompt_kernel_P2
gated_mix__ssm_conv_s5__ssm_conv_s4__prompt_kernel_S4:
    s_setprio 3
    s_sub_u32 s60, s3, 4
    s_lshr_b32 s61, s60, 1
    s_and_b32 s62, s60, 1
    s_lshl_b32 s63, s2, 1
    s_add_u32 s63, s63, s61
    s_mul_i32 s64, s61, 11008
    s_add_u32 s64, s64, 131072
    s_xor_b32 s65, s62, 1
    s_lshl_b32 s65, s65, 12
    s_add_u32 s65, s65, s64
    s_add_u32 s65, s65, 2816
    s_lshl_b32 s14, s6, 7
    s_lshl_b32 s15, s62, 6
    s_add_u32 s14, s14, s15
    s_lshl_b32 s15, s7, 5
    s_lshl_b32 s11, s61, 4
    s_add_u32 s15, s15, s11
    s_lshl_b32 s12, s14, 10
    s_lshl_b32 s13, s15, 1
    s_add_u32 s12, s12, s13
    v_and_b32 v4, 7, v1
    v_lshrrev_b32 v5, 3, v1
    v_lshlrev_b32 v6, 13, v5
    v_lshl_add_u32 v6, v4, 2, v6
    v_add_u32 v6, s12, v6
    v_add_u32 v7, 4096, v6
    global_load_dword v64, v6, s[16:17] offset:0
    global_load_dword v65, v6, s[16:17] offset:1024
    global_load_dword v66, v6, s[16:17] offset:2048
    global_load_dword v67, v6, s[16:17] offset:3072
    global_load_dword v68, v7, s[16:17] offset:0
    global_load_dword v69, v7, s[16:17] offset:1024
    global_load_dword v70, v7, s[16:17] offset:2048
    global_load_dword v71, v7, s[16:17] offset:3072
    s_lshl_b32 s12, s63, 8
    s_lshl_b32 s13, s62, 7
    s_add_u32 s12, s12, s13
    v_lshl_add_u32 v8, v1, 1, s12
    s_lshl_b32 s12, s63, 1
    v_mov_b32 v9, s12
    v_mov_b32 v12, 0
    global_load_ushort v86, v9, s[48:49]
    global_load_ushort v80, v8, s[36:37]
    global_load_ushort v81, v8, s[38:39]
    global_load_ushort v82, v8, s[40:41]
    global_load_ushort v83, v8, s[42:43]
    global_load_ushort v84, v8, s[44:45]
    global_load_ushort v85, v8, s[46:47]
    s_barrier
    s_lshl_b32 s12, s15, 12
    s_lshl_b32 s13, s14, 1
    s_add_u32 s12, s12, s13
    s_add_u32 s12, s12, 0
    v_lshlrev_b32 v131, 13, v4
    v_lshl_add_u32 v131, v5, 4, v131
    v_add_u32 v131, s12, v131
    v_add_u32 v132, 4096, v131
    s_lshl_b32 s12, s7, 1
    s_add_u32 s12, s12, s61
    s_lshl_b32 s12, s12, 4
    s_add_u32 s12, s12, s6
    s_lshl_b32 s12, s12, 1
    s_add_u32 s12, s12, s62
    s_lshl_b32 s12, s12, 2
    s_add_u32 s66, s12, 8519680
    s_lshl_b32 s12, s3, 2
    s_add_u32 s12, s12, 153088
    v_mov_b32 v14, s12
    v_xor_b32 v15, 4, v14
    v_lshl_add_u32 v108, v1, 2, s65
    v_lshl_add_u32 v29, v1, 4, s65
    v_and_b32 v4, 15, v1
    v_lshrrev_b32 v5, 4, v1
    v_xor_b32 v6, v4, v5
    v_lshlrev_b32 v6, 4, v6
    v_lshl_add_u32 v6, v4, 8, v6
    v_add_u32 v124, s65, v6
    v_xor_b32 v109, 16, v108
    v_xor_b32 v110, 32, v108
    v_xor_b32 v111, 48, v108
    v_xor_b32 v112, 64, v108
    v_xor_b32 v113, 80, v108
    v_xor_b32 v114, 96, v108
    v_xor_b32 v115, 112, v108
    v_xor_b32 v116, 128, v108
    v_xor_b32 v117, 144, v108
    v_xor_b32 v118, 160, v108
    v_xor_b32 v119, 176, v108
    v_xor_b32 v120, 192, v108
    v_xor_b32 v121, 208, v108
    v_xor_b32 v122, 224, v108
    v_xor_b32 v123, 240, v108
    v_xor_b32 v125, 64, v124
    v_xor_b32 v126, 128, v124
    v_xor_b32 v127, 192, v124
    s_add_u32 s12, s64, 16
    v_lshlrev_b32 v6, 4, v5
    v_lshl_add_u32 v128, v4, 6, v6
    v_add_u32 v128, s12, v128
    v_lshl_add_u32 v7, v4, 5, v6
    v_lshlrev_b32 v8, 8, v5
    v_lshl_add_u32 v9, v4, 4, v8
    v_cmp_gt_u32 vcc, 2, v5
    s_nop 1
    v_cndmask_b32 v129, v9, v7, vcc
    v_add_u32 v129, s12, v129
    v_lshl_add_u32 v130, v4, 3, v8
    v_add_u32 v130, s12, v130
    s_lshl_b32 s12, s62, 9
    s_add_u32 s12, s12, s64
    s_add_u32 s12, s12, 2856
    v_lshlrev_b32 v6, 5, v5
    v_lshl_add_u32 v19, v4, 2, s12
    v_sub_u32 v19, v19, v6
    s_mul_i32 s12, s61, 4608
    s_add_u32 s67, s12, 153120
    s_lshl_b32 s13, s62, 8
    s_sub_u32 s12, s67, s13
    s_add_u32 s12, s12, 288
    v_lshlrev_b32 v6, 4, v5
    v_lshl_add_u32 v27, v4, 5, v6
    v_add_u32 v27, s12, v27
    s_lshl_b32 s12, s63, 12
    s_lshl_b32 s13, s62, 11
    s_add_u32 s68, s12, s13
    s_add_u32 s12, s68, 6291456
    v_and_b32 v6, 1, v5
    v_lshlrev_b32 v6, 9, v6
    v_lshl_add_u32 v6, v4, 5, v6
    v_lshrrev_b32 v7, 1, v5
    v_lshl_add_u32 v6, v7, 4, v6
    v_add_u32 v28, s12, v6
    s_lshr_b32 s12, s2, 3
    s_lshl_b32 s12, s12, 7
    s_add_u32 s12, s12, 8519680
    v_and_b32 v6, 31, v1
    v_lshl_add_u32 v16, v6, 2, s12
    v_add_u32 v20, 1024, v19
    v_add_u32 v21, 2048, v19
    v_add_u32 v22, 3072, v19
    v_add_u32 v23, 4096, v19
    v_add_u32 v24, 5120, v19
    v_add_u32 v25, 6144, v19
    v_add_u32 v26, 7168, v19
    s_lshl_b32 s12, s62, 10
    s_sub_u32 s12, s12, 1
    v_lshl_add_u32 v4, v1, 2, s12
    v_cvt_f32_i32 v5, v4
    s_add_u32 s13, s64, 16
    s_sub_u32 s12, s13, 68096
    v_mov_b32 v11, s12
    v_lshl_add_u32 v10, v4, 2, s13
    s_cmp_eq_u32 s62, 0
    s_cselect_b64 vcc, -1, 0
    v_mov_b32 v190, v5
    v_add_f32 v191, 0x3f800000, v5
    v_cvt_pk_bf16_f32 v6, v190, v191
    v_mad_u32_u16 v88, v6, 4, v11
    v_mad_u32_u16 v89, v6, 4, v11 op_sel:[1,0,0,0]
    v_add_f32 v190, 0x40000000, v5
    v_add_f32 v191, 0x40400000, v5
    v_cvt_pk_bf16_f32 v6, v190, v191
    v_mad_u32_u16 v90, v6, 4, v11
    v_mad_u32_u16 v91, v6, 4, v11 op_sel:[1,0,0,0]
    v_add_f32 v190, 0x40800000, v5
    v_cvt_pk_bf16_f32 v6, v190, v191
    v_mad_u32_u16 v92, v6, 4, v11
    v_add_f32 v190, 0x43800000, v5
    v_add_f32 v191, 0x43808000, v5
    v_cvt_pk_bf16_f32 v6, v190, v191
    v_mad_u32_u16 v93, v6, 4, v11
    v_mad_u32_u16 v94, v6, 4, v11 op_sel:[1,0,0,0]
    v_add_f32 v190, 0x43810000, v5
    v_add_f32 v191, 0x43818000, v5
    v_cvt_pk_bf16_f32 v6, v190, v191
    v_mad_u32_u16 v95, v6, 4, v11
    v_mad_u32_u16 v96, v6, 4, v11 op_sel:[1,0,0,0]
    v_add_f32 v190, 0x43820000, v5
    v_cvt_pk_bf16_f32 v6, v190, v191
    v_mad_u32_u16 v97, v6, 4, v11
    v_add_f32 v190, 0x44000000, v5
    v_add_f32 v191, 0x44004000, v5
    v_cvt_pk_bf16_f32 v6, v190, v191
    v_mad_u32_u16 v98, v6, 4, v11
    v_mad_u32_u16 v99, v6, 4, v11 op_sel:[1,0,0,0]
    v_add_f32 v190, 0x44008000, v5
    v_add_f32 v191, 0x4400c000, v5
    v_cvt_pk_bf16_f32 v6, v190, v191
    v_mad_u32_u16 v100, v6, 4, v11
    v_mad_u32_u16 v101, v6, 4, v11 op_sel:[1,0,0,0]
    v_add_f32 v190, 0x44010000, v5
    v_cvt_pk_bf16_f32 v6, v190, v191
    v_mad_u32_u16 v102, v6, 4, v11
    v_add_f32 v190, 0x44400000, v5
    v_add_f32 v191, 0x44404000, v5
    v_cvt_pk_bf16_f32 v6, v190, v191
    v_mad_u32_u16 v103, v6, 4, v11
    v_mad_u32_u16 v104, v6, 4, v11 op_sel:[1,0,0,0]
    v_add_f32 v190, 0x44408000, v5
    v_add_f32 v191, 0x4440c000, v5
    v_cvt_pk_bf16_f32 v6, v190, v191
    v_mad_u32_u16 v105, v6, 4, v11
    v_mad_u32_u16 v106, v6, 4, v11 op_sel:[1,0,0,0]
    v_add_f32 v190, 0x44410000, v5
    v_cvt_pk_bf16_f32 v6, v190, v191
    v_mad_u32_u16 v107, v6, 4, v11
    v_add_u32 v6, 0, v10
    v_cndmask_b32 v88, v88, v6, vcc
    v_add_u32 v6, 4, v10
    v_cndmask_b32 v89, v89, v6, vcc
    v_add_u32 v6, 8, v10
    v_cndmask_b32 v90, v90, v6, vcc
    v_add_u32 v6, 12, v10
    v_cndmask_b32 v91, v91, v6, vcc
    v_add_u32 v6, 16, v10
    v_cndmask_b32 v92, v92, v6, vcc
    s_waitcnt vmcnt(7)
    s_mov_b32 s12, 0x05040100
    s_mov_b32 s13, 0x07060302
    v_perm_b32 v72, v65, v64, s12
    v_perm_b32 v76, v65, v64, s13
    v_perm_b32 v73, v67, v66, s12
    v_perm_b32 v77, v67, v66, s13
    v_perm_b32 v74, v69, v68, s12
    v_perm_b32 v78, v69, v68, s13
    v_perm_b32 v75, v71, v70, s12
    v_perm_b32 v79, v71, v70, s13
    global_store_dwordx4 v131, v[72:75], s[58:59] sc1
    global_store_dwordx4 v132, v[76:79], s[58:59] sc1
    global_load_dword v13, v12, s[56:57] sc1
    s_waitcnt vmcnt(3)
    v_lshlrev_b32 v80, 16, v80
    v_lshlrev_b32 v81, 16, v81
    v_lshlrev_b32 v82, 16, v82
    v_lshlrev_b32 v83, 16, v83
    v_lshlrev_b32 v84, 16, v84
    v_lshlrev_b32 v85, 16, v85
    v_lshlrev_b32 v86, 16, v86
    v_mul_f32 v86, 0x3fb8aa3b, v86
    v_exp_f32 v86, v86
    s_nop 0
    v_cvt_pk_bf16_f32 v86, v86, v86
    v_lshlrev_b32 v86, 16, v86
    v_mul_f32 v17, v86, v80
    v_mul_f32 v18, v86, v81
    v_mul_f32 v17, 0x3fb8aa3b, v17
    v_mul_f32 v18, 0x3e22f983, v18
    v_mul_f32 v82, v86, v82
    v_mul_f32 v83, v86, v83
    v_mul_f32 v184, v84, v82
    v_mul_f32 v185, v84, v83
    v_fma_f32 v184, -v85, v83, v184
    v_fmac_f32 v185, v85, v82
    v_mul_f32 v4, 0x41800000, v17
    v_mul_f32 v5, 0x41800000, v18
    v_exp_f32 v4, v4
    v_fract_f32 v5, v5
    v_cos_f32 v188, v5
    v_sin_f32 v189, v5
    v_mul_f32 v188, v188, v4
    v_mul_f32 v189, v189, v4
    v_mul_f32 v6, 1.0, v17
    v_mul_f32 v7, 1.0, v18
    v_exp_f32 v6, v6
    v_fract_f32 v7, v7
    v_cos_f32 v136, v7
    v_sin_f32 v137, v7
    v_mul_f32 v136, v136, v6
    v_mul_f32 v137, v137, v6
    v_mul_f32 v8, 0x43800000, v17
    v_mul_f32 v9, 0x43800000, v18
    v_exp_f32 v8, v8
    v_fract_f32 v9, v9
    v_cos_f32 v168, v9
    v_sin_f32 v169, v9
    v_mul_f32 v168, v168, v8
    v_mul_f32 v169, v169, v8
    v_mul_f32 v186, v184, v188
    v_mul_f32 v187, v184, v189
    v_fma_f32 v186, -v185, v189, v186
    v_fmac_f32 v187, v185, v188
    v_cvt_pk_bf16_f32 v190, v184, -v185
    ds_write_b32 v108, v190 offset:0
    v_mul_f32 v138, v136, v136
    v_mul_f32 v139, v136, v137
    v_fma_f32 v138, -v137, v137, v138
    v_fmac_f32 v139, v137, v136
    v_mul_f32 v184, v186, v188
    v_mul_f32 v185, v186, v189
    v_fma_f32 v184, -v187, v189, v184
    v_fmac_f32 v185, v187, v188
    v_cvt_pk_bf16_f32 v191, v186, -v187
    ds_write_b32 v109, v191 offset:256
    v_mul_f32 v140, v138, v136
    v_mul_f32 v141, v138, v137
    v_fma_f32 v140, -v139, v137, v140
    v_fmac_f32 v141, v139, v136
    v_mul_f32 v186, v184, v188
    v_mul_f32 v187, v184, v189
    v_fma_f32 v186, -v185, v189, v186
    v_fmac_f32 v187, v185, v188
    v_cvt_pk_bf16_f32 v192, v184, -v185
    ds_write_b32 v110, v192 offset:512
    v_mul_f32 v142, v138, v138
    v_mul_f32 v143, v138, v139
    v_fma_f32 v142, -v139, v139, v142
    v_fmac_f32 v143, v139, v138
    v_mul_f32 v184, v186, v188
    v_mul_f32 v185, v186, v189
    v_fma_f32 v184, -v187, v189, v184
    v_fmac_f32 v185, v187, v188
    v_cvt_pk_bf16_f32 v193, v186, -v187
    ds_write_b32 v111, v193 offset:768
    v_mul_f32 v144, v142, v136
    v_mul_f32 v145, v142, v137
    v_fma_f32 v144, -v143, v137, v144
    v_fmac_f32 v145, v143, v136
    v_mul_f32 v186, v184, v188
    v_mul_f32 v187, v184, v189
    v_fma_f32 v186, -v185, v189, v186
    v_fmac_f32 v187, v185, v188
    v_cvt_pk_bf16_f32 v190, v184, -v185
    ds_write_b32 v112, v190 offset:1024
    v_mul_f32 v146, v140, v140
    v_mul_f32 v147, v140, v141
    v_fma_f32 v146, -v141, v141, v146
    v_fmac_f32 v147, v141, v140
    v_mul_f32 v184, v186, v188
    v_mul_f32 v185, v186, v189
    v_fma_f32 v184, -v187, v189, v184
    v_fmac_f32 v185, v187, v188
    v_cvt_pk_bf16_f32 v191, v186, -v187
    ds_write_b32 v113, v191 offset:1280
    v_mul_f32 v148, v146, v136
    v_mul_f32 v149, v146, v137
    v_fma_f32 v148, -v147, v137, v148
    v_fmac_f32 v149, v147, v136
    v_mul_f32 v186, v184, v188
    v_mul_f32 v187, v184, v189
    v_fma_f32 v186, -v185, v189, v186
    v_fmac_f32 v187, v185, v188
    v_cvt_pk_bf16_f32 v192, v184, -v185
    ds_write_b32 v114, v192 offset:1536
    v_mul_f32 v150, v142, v142
    v_mul_f32 v151, v142, v143
    v_fma_f32 v150, -v143, v143, v150
    v_fmac_f32 v151, v143, v142
    v_mul_f32 v184, v186, v188
    v_mul_f32 v185, v186, v189
    v_fma_f32 v184, -v187, v189, v184
    v_fmac_f32 v185, v187, v188
    v_cvt_pk_bf16_f32 v193, v186, -v187
    ds_write_b32 v115, v193 offset:1792
    v_mul_f32 v152, v150, v136
    v_mul_f32 v153, v150, v137
    v_fma_f32 v152, -v151, v137, v152
    v_fmac_f32 v153, v151, v136
    v_mul_f32 v186, v184, v188
    v_mul_f32 v187, v184, v189
    v_fma_f32 v186, -v185, v189, v186
    v_fmac_f32 v187, v185, v188
    v_cvt_pk_bf16_f32 v190, v184, -v185
    ds_write_b32 v116, v190 offset:2048
    v_mul_f32 v154, v144, v144
    v_mul_f32 v155, v144, v145
    v_fma_f32 v154, -v145, v145, v154
    v_fmac_f32 v155, v145, v144
    v_mul_f32 v184, v186, v188
    v_mul_f32 v185, v186, v189
    v_fma_f32 v184, -v187, v189, v184
    v_fmac_f32 v185, v187, v188
    v_cvt_pk_bf16_f32 v191, v186, -v187
    ds_write_b32 v117, v191 offset:2304
    v_mul_f32 v156, v154, v136
    v_mul_f32 v157, v154, v137
    v_fma_f32 v156, -v155, v137, v156
    v_fmac_f32 v157, v155, v136
    v_mul_f32 v186, v184, v188
    v_mul_f32 v187, v184, v189
    v_fma_f32 v186, -v185, v189, v186
    v_fmac_f32 v187, v185, v188
    v_cvt_pk_bf16_f32 v192, v184, -v185
    ds_write_b32 v118, v192 offset:2560
    v_mul_f32 v158, v146, v146
    v_mul_f32 v159, v146, v147
    v_fma_f32 v158, -v147, v147, v158
    v_fmac_f32 v159, v147, v146
    v_mul_f32 v184, v186, v188
    v_mul_f32 v185, v186, v189
    v_fma_f32 v184, -v187, v189, v184
    v_fmac_f32 v185, v187, v188
    v_cvt_pk_bf16_f32 v193, v186, -v187
    ds_write_b32 v119, v193 offset:2816
    v_mul_f32 v160, v158, v136
    v_mul_f32 v161, v158, v137
    v_fma_f32 v160, -v159, v137, v160
    v_fmac_f32 v161, v159, v136
    v_mul_f32 v186, v184, v188
    v_mul_f32 v187, v184, v189
    v_fma_f32 v186, -v185, v189, v186
    v_fmac_f32 v187, v185, v188
    v_cvt_pk_bf16_f32 v190, v184, -v185
    ds_write_b32 v120, v190 offset:3072
    v_mul_f32 v162, v148, v148
    v_mul_f32 v163, v148, v149
    v_fma_f32 v162, -v149, v149, v162
    v_fmac_f32 v163, v149, v148
    v_mul_f32 v184, v186, v188
    v_mul_f32 v185, v186, v189
    v_fma_f32 v184, -v187, v189, v184
    v_fmac_f32 v185, v187, v188
    v_cvt_pk_bf16_f32 v191, v186, -v187
    ds_write_b32 v121, v191 offset:3328
    v_mul_f32 v164, v162, v136
    v_mul_f32 v165, v162, v137
    v_fma_f32 v164, -v163, v137, v164
    v_fmac_f32 v165, v163, v136
    v_mul_f32 v186, v184, v188
    v_mul_f32 v187, v184, v189
    v_fma_f32 v186, -v185, v189, v186
    v_fmac_f32 v187, v185, v188
    v_cvt_pk_bf16_f32 v192, v184, -v185
    ds_write_b32 v122, v192 offset:3584
    v_cvt_pk_bf16_f32 v193, v186, -v187
    ds_write_b32 v123, v193 offset:3840
    ds_read_b128 v[196:199], v124
    ds_read_b128 v[200:203], v125
    ds_read_b128 v[204:207], v126
    ds_read_b128 v[208:211], v127
    v_mov_b32 v134, 1.0
    v_mov_b32 v135, 0
    v_cvt_pk_bf16_f32 v190, v134, v135
    ds_write_b32 v108, v190 offset:0
    v_mul_f32 v170, v168, v168
    v_mul_f32 v171, v168, v169
    v_fma_f32 v170, -v169, v169, v170
    v_fmac_f32 v171, v169, v168
    v_cvt_pk_bf16_f32 v191, v136, v137
    ds_write_b32 v109, v191 offset:256
    v_mul_f32 v172, v170, v168
    v_mul_f32 v173, v170, v169
    v_fma_f32 v172, -v171, v169, v172
    v_fmac_f32 v173, v171, v168
    v_cvt_pk_bf16_f32 v192, v138, v139
    ds_write_b32 v110, v192 offset:512
    v_mul_f32 v174, v170, v170
    v_mul_f32 v175, v170, v171
    v_fma_f32 v174, -v171, v171, v174
    v_fmac_f32 v175, v171, v170
    v_cvt_pk_bf16_f32 v193, v140, v141
    ds_write_b32 v111, v193 offset:768
    v_mul_f32 v178, v172, v172
    v_mul_f32 v179, v172, v173
    v_fma_f32 v178, -v173, v173, v178
    v_fmac_f32 v179, v173, v172
    v_cvt_pk_bf16_f32 v190, v142, v143
    ds_write_b32 v112, v190 offset:1024
    v_mul_f32 v176, v174, v168
    v_mul_f32 v177, v174, v169
    v_fma_f32 v176, -v175, v169, v176
    v_fmac_f32 v177, v175, v168
    v_cvt_pk_bf16_f32 v191, v144, v145
    ds_write_b32 v113, v191 offset:1280
    v_mul_f32 v182, v174, v174
    v_mul_f32 v183, v174, v175
    v_fma_f32 v182, -v175, v175, v182
    v_fmac_f32 v183, v175, v174
    v_cvt_pk_bf16_f32 v192, v146, v147
    ds_write_b32 v114, v192 offset:1536
    v_mul_f32 v180, v178, v168
    v_mul_f32 v181, v178, v169
    v_fma_f32 v180, -v179, v169, v180
    v_fmac_f32 v181, v179, v168
    v_cvt_pk_bf16_f32 v193, v148, v149
    ds_write_b32 v115, v193 offset:1792
    v_cvt_pk_bf16_f32 v190, v150, v151
    ds_write_b32 v116, v190 offset:2048
    v_cvt_pk_bf16_f32 v191, v152, v153
    ds_write_b32 v117, v191 offset:2304
    v_cvt_pk_bf16_f32 v192, v154, v155
    ds_write_b32 v118, v192 offset:2560
    v_cvt_pk_bf16_f32 v193, v156, v157
    ds_write_b32 v119, v193 offset:2816
    v_cvt_pk_bf16_f32 v190, v158, v159
    ds_write_b32 v120, v190 offset:3072
    v_cvt_pk_bf16_f32 v191, v160, v161
    ds_write_b32 v121, v191 offset:3328
    v_cvt_pk_bf16_f32 v192, v162, v163
    ds_write_b32 v122, v192 offset:3584
    v_cvt_pk_bf16_f32 v193, v164, v165
    ds_write_b32 v123, v193 offset:3840
    ds_read_b128 v[212:215], v124
    ds_read_b128 v[216:219], v125
    ds_read_b128 v[220:223], v126
    ds_read_b128 v[224:227], v127
    s_waitcnt vmcnt(0)
    v_readfirstlane_b32 s10, v13
    s_cmp_lg_u32 s10, 0
    s_cbranch_scc1 gated_mix__ssm_conv_s5__ssm_conv_s4__prompt_kernel_TD27
    s_mov_b32 s11, 1048576
gated_mix__ssm_conv_s5__ssm_conv_s4__prompt_kernel_TG26:
    global_load_dword v13, v12, s[56:57] sc1
    s_waitcnt vmcnt(0)
    v_readfirstlane_b32 s10, v13
    s_sub_u32 s11, s11, 1
    s_cmp_eq_u32 s11, 0
    s_cbranch_scc1 gated_mix__ssm_conv_s5__ssm_conv_s4__prompt_kernel_TD27
    s_cmp_eq_u32 s10, 0
    s_cbranch_scc1 gated_mix__ssm_conv_s5__ssm_conv_s4__prompt_kernel_TG26
gated_mix__ssm_conv_s5__ssm_conv_s4__prompt_kernel_TD27:
    v_mov_b32 v4, s66
    v_mov_b32 v5, s10
    s_waitcnt vmcnt(0)
    s_mov_b64 exec, 1
    global_store_dword v4, v5, s[58:59] sc1
    s_mov_b64 exec, -1
    s_cmp_lg_u32 s3, 5
    s_cbranch_scc1 gated_mix__ssm_conv_s5__ssm_conv_s4__prompt_kernel_NA28
    v_mov_b32 v6, s0
    v_mov_b32 v7, s1
    v_lshrrev_b32 v6, 5, v6
    s_mov_b64 exec, 1
    global_atomic_add v7, v6, s[56:57]
    s_mov_b64 exec, -1
gated_mix__ssm_conv_s5__ssm_conv_s4__prompt_kernel_NA28:
    s_mov_b64 exec, 15
    s_lshl_b32 s12, s8, 17
    v_mov_b32 v32, s12
    s_lshl_b32 s12, s9, 16
    v_mov_b32 v33, s12
    v_lshlrev_b32 v34, 21, v1
    v_add_u32 v34, 2097152, v34
    v_lshrrev_b32 v36, 9, v33
    global_load_dword v35, v36, s[32:33]
    global_load_dword v36, v36, s[50:51]
    global_load_dword v34, v34, s[58:59] sc1
    global_load_dword v32, v32, s[54:55]
    global_load_dword v37, v33, s[26:27]
    global_load_dword v33, v33, s[28:29]
    s_mov_b64 exec, -1
    v_cvt_pk_bf16_f32 v190, v168, v169
    ds_write_b32 v108, v190 offset:0
    v_mul_f32 v186, v168, v138
    v_mul_f32 v187, v168, v139
    v_fma_f32 v186, -v169, v139, v186
    v_fmac_f32 v187, v169, v138
    v_cvt_pk_bf16_f32 v191, v186, v187
    ds_write_b32 v109, v191 offset:256
    v_mul_f32 v184, v168, v142
    v_mul_f32 v185, v168, v143
    v_fma_f32 v184, -v169, v143, v184
    v_fmac_f32 v185, v169, v142
    v_cvt_pk_bf16_f32 v192, v184, v185
    ds_write_b32 v110, v192 offset:512
    v_mul_f32 v186, v168, v146
    v_mul_f32 v187, v168, v147
    v_fma_f32 v186, -v169, v147, v186
    v_fmac_f32 v187, v169, v146
    v_cvt_pk_bf16_f32 v193, v186, v187
    ds_write_b32 v111, v193 offset:768
    v_mul_f32 v184, v168, v150
    v_mul_f32 v185, v168, v151
    v_fma_f32 v184, -v169, v151, v184
    v_fmac_f32 v185, v169, v150
    v_cvt_pk_bf16_f32 v190, v184, v185
    ds_write_b32 v112, v190 offset:1024
    v_mul_f32 v186, v168, v154
    v_mul_f32 v187, v168, v155
    v_fma_f32 v186, -v169, v155, v186
    v_fmac_f32 v187, v169, v154
    v_cvt_pk_bf16_f32 v191, v186, v187
    ds_write_b32 v113, v191 offset:1280
    v_mul_f32 v184, v168, v158
    v_mul_f32 v185, v168, v159
    v_fma_f32 v184, -v169, v159, v184
    v_fmac_f32 v185, v169, v158
    v_cvt_pk_bf16_f32 v192, v184, v185
    ds_write_b32 v114, v192 offset:1536
    v_mul_f32 v186, v168, v162
    v_mul_f32 v187, v168, v163
    v_fma_f32 v186, -v169, v163, v186
    v_fmac_f32 v187, v169, v162
    v_cvt_pk_bf16_f32 v193, v186, v187
    ds_write_b32 v115, v193 offset:1792
    v_cvt_pk_bf16_f32 v190, v170, v171
    ds_write_b32 v116, v190 offset:2048
    v_mul_f32 v186, v170, v142
    v_mul_f32 v187, v170, v143
    v_fma_f32 v186, -v171, v143, v186
    v_fmac_f32 v187, v171, v142
    v_cvt_pk_bf16_f32 v191, v186, v187
    ds_write_b32 v117, v191 offset:2304
    v_mul_f32 v184, v170, v150
    v_mul_f32 v185, v170, v151
    v_fma_f32 v184, -v171, v151, v184
    v_fmac_f32 v185, v171, v150
    v_cvt_pk_bf16_f32 v192, v184, v185
    ds_write_b32 v118, v192 offset:2560
    v_mul_f32 v186, v170, v158
    v_mul_f32 v187, v170, v159
    v_fma_f32 v186, -v171, v159, v186
    v_fmac_f32 v187, v171, v158
    v_cvt_pk_bf16_f32 v193, v186, v187
    ds_write_b32 v119, v193 offset:2816
    v_cvt_pk_bf16_f32 v190, v172, v173
    ds_write_b32 v120, v190 offset:3072
    v_mul_f32 v186, v172, v142
    v_mul_f32 v187, v172, v143
    v_fma_f32 v186, -v173, v143, v186
    v_fmac_f32 v187, v173, v142
    v_cvt_pk_bf16_f32 v191, v186, v187
    ds_write_b32 v121, v191 offset:3328
    v_mul_f32 v184, v172, v150
    v_mul_f32 v185, v172, v151
    v_fma_f32 v184, -v173, v151, v184
    v_fmac_f32 v185, v173, v150
    v_cvt_pk_bf16_f32 v192, v184, v185
    ds_write_b32 v122, v192 offset:3584
    v_mul_f32 v186, v172, v158
    v_mul_f32 v187, v172, v159
    v_fma_f32 v186, -v173, v159, v186
    v_fmac_f32 v187, v173, v158
    v_cvt_pk_bf16_f32 v193, v186, v187
    ds_write_b32 v123, v193 offset:3840
    ds_read_b128 v[228:231], v124
    ds_read_b128 v[232:235], v125
    ds_read_b128 v[236:239], v126
    ds_read_b128 v[240:243], v127
    s_waitcnt lgkmcnt(15)
    v_mfma_f32_16x16x32_bf16 v[244:247], v[212:215], v[196:199], 0
    v_mfma_f32_16x16x32_bf16 v[244:247], v[216:219], v[200:203], v[244:247]
    v_mfma_f32_16x16x32_bf16 v[244:247], v[220:223], v[204:207], v[244:247]
    v_mfma_f32_16x16x32_bf16 v[244:247], v[224:227], v[208:211], v[244:247]
    v_cvt_pk_bf16_f32 v190, v174, v175
    ds_write_b32 v108, v190 offset:0
    v_mul_f32 v186, v174, v150
    v_mul_f32 v187, v174, v151
    v_fma_f32 v186, -v175, v151, v186
    v_fmac_f32 v187, v175, v150
    v_cvt_pk_bf16_f32 v191, v186, v187
    ds_write_b32 v109, v191 offset:256
    v_cvt_pk_bf16_f32 v192, v176, v177
    ds_write_b32 v110, v192 offset:512
    v_mul_f32 v186, v176, v150
    v_mul_f32 v187, v176, v151
    v_fma_f32 v186, -v177, v151, v186
    v_fmac_f32 v187, v177, v150
    v_cvt_pk_bf16_f32 v193, v186, v187
    ds_write_b32 v111, v193 offset:768
    v_cvt_pk_bf16_f32 v190, v178, v179
    ds_write_b32 v112, v190 offset:1024
    v_mul_f32 v186, v178, v150
    v_mul_f32 v187, v178, v151
    v_fma_f32 v186, -v179, v151, v186
    v_fmac_f32 v187, v179, v150
    v_cvt_pk_bf16_f32 v191, v186, v187
    ds_write_b32 v113, v191 offset:1280
    v_cvt_pk_bf16_f32 v192, v180, v181
    ds_write_b32 v114, v192 offset:1536
    v_mul_f32 v186, v180, v150
    v_mul_f32 v187, v180, v151
    v_fma_f32 v186, -v181, v151, v186
    v_fmac_f32 v187, v181, v150
    v_cvt_pk_bf16_f32 v193, v186, v187
    ds_write_b32 v115, v193 offset:1792
    v_cvt_pk_bf16_f32 v190, v182, v183
    ds_write_b32 v116, v190 offset:2048
    ds_read_b128 v[212:215], v124
    ds_read_b128 v[216:219], v125
    ds_read_b128 v[220:223], v126
    ds_read_b128 v[224:227], v127
    s_waitcnt lgkmcnt(13)
    v_mfma_f32_16x16x32_bf16 v[248:251], v[228:231], v[196:199], 0
    v_mfma_f32_16x16x32_bf16 v[248:251], v[232:235], v[200:203], v[248:251]
    v_mfma_f32_16x16x32_bf16 v[248:251], v[236:239], v[204:207], v[248:251]
    v_mfma_f32_16x16x32_bf16 v[248:251], v[240:243], v[208:211], v[248:251]
    ds_write_b128 v29, v[244:247]
    s_waitcnt lgkmcnt(1)
    v_mfma_f32_16x16x32_bf16 v[252:255], v[212:215], v[196:199], 0
    v_mfma_f32_16x16x32_bf16 v[252:255], v[216:219], v[200:203], v[252:255]
    v_mfma_f32_16x16x32_bf16 v[252:255], v[220:223], v[204:207], v[252:255]
    v_mfma_f32_16x16x32_bf16 v[252:255], v[224:227], v[208:211], v[252:255]
    s_nop 1
    ds_write_b128 v29, v[248:251] offset:1024
    global_load_dword v10, v16, s[58:59] sc1
    s_lshl_b32 s12, s62, 12
    s_add_u32 s12, s12, s64
    s_add_u32 s12, s12, 2816
    v_lshl_add_u32 v30, v1, 4, s12
    ds_write_b128 v29, v[252:255] offset:2048
    v_mov_b32 v4, 1
    ds_write_b32 v14, v4
    s_mov_b32 s11, 1048576
gated_mix__ssm_conv_s5__ssm_conv_s4__prompt_kernel_PW29:
    ds_read_b32 v4, v15
    s_waitcnt lgkmcnt(0)
    s_sub_u32 s11, s11, 1
    v_readfirstlane_b32 s14, v4
    s_cmp_eq_u32 s11, 0
    s_cbranch_scc1 gated_mix__ssm_conv_s5__ssm_conv_s4__prompt_kernel_PD30
    s_cmp_lt_u32 s14, 1
    s_cbranch_scc1 gated_mix__ssm_conv_s5__ssm_conv_s4__prompt_kernel_PW29
gated_mix__ssm_conv_s5__ssm_conv_s4__prompt_kernel_PD30:
    v_lshl_add_u32 v8, v1, 4, s68
    s_lshl_b32 s12, s62, 11
    s_add_u32 s12, s12, s67
    v_lshl_add_u32 v9, v1, 4, s12
    s_waitcnt vmcnt(0)
    v_cmp_ne_u32 s[70:71], s10, v10
    s_cmp_lg_u64 s[70:71], 0
    s_cbranch_scc1 gated_mix__ssm_conv_s5__ssm_conv_s4__prompt_kernel_FA31
    global_load_dwordx4 v[64:67], v8, s[58:59] sc1
    global_load_dwordx4 v[68:71], v8, s[58:59] offset:1024 sc1
    s_branch gated_mix__ssm_conv_s5__ssm_conv_s4__prompt_kernel_FB32
gated_mix__ssm_conv_s5__ssm_conv_s4__prompt_kernel_FA31:
    global_load_dword v10, v16, s[58:59] sc1
gated_mix__ssm_conv_s5__ssm_conv_s4__prompt_kernel_FB32:
    ds_read_b128 v[212:215], v30 offset:0
    ds_read_b128 v[216:219], v30 offset:1024
    ds_read_b128 v[220:223], v30 offset:2048
    s_waitcnt lgkmcnt(2)
    v_add_f32 v244, v244, v212
    v_add_f32 v245, v245, v213
    v_add_f32 v246, v246, v214
    v_add_f32 v247, v247, v215
    ds_write_b128 v128, v[244:247] offset:0
    s_waitcnt lgkmcnt(2)
    v_add_f32 v248, v248, v216
    v_add_f32 v249, v249, v217
    v_add_f32 v250, v250, v218
    v_add_f32 v251, v251, v219
    ds_write_b128 v129, v[248:251] offset:1024
    s_waitcnt lgkmcnt(2)
    v_add_f32 v252, v252, v220
    v_add_f32 v253, v253, v221
    v_add_f32 v254, v254, v222
    v_add_f32 v255, v255, v223
    s_mov_b32 exec_hi, 1
    ds_write_b64 v130, v[252:253] offset:2048
    s_mov_b32 exec_hi, 0
    ds_write_b64 v130, v[254:255] offset:2176
    s_mov_b32 exec_hi, -1
    ds_read_b32 v134, v88
    ds_read_b32 v135, v89
    ds_read_b32 v136, v90
    ds_read_b32 v137, v91
    ds_read_b32 v138, v92
    ds_read_b32 v139, v93
    ds_read_b32 v140, v94
    ds_read_b32 v141, v95
    ds_read_b32 v142, v96
    ds_read_b32 v143, v97
    ds_read_b32 v144, v98
    ds_read_b32 v145, v99
    ds_read_b32 v146, v100
    ds_read_b32 v147, v101
    ds_read_b32 v148, v102
    s_waitcnt lgkmcnt(10)
    ds_read_b32 v149, v103
    ds_read_b32 v150, v104
    ds_read_b32 v151, v105
    ds_read_b32 v152, v106
    ds_read_b32 v153, v107
    s_waitcnt lgkmcnt(15)
    v_cvt_pk_bf16_f32 v196, v135, v134
    v_cvt_pk_bf16_f32 v197, v136, v135
    v_cvt_pk_bf16_f32 v198, v137, v136
    v_cvt_pk_bf16_f32 v199, v138, v137
    ds_write_b128 v30, v[196:199] offset:0
    s_waitcnt lgkmcnt(11)
    v_cvt_pk_bf16_f32 v200, v140, v139
    v_cvt_pk_bf16_f32 v201, v141, v140
    v_cvt_pk_bf16_f32 v202, v142, v141
    v_cvt_pk_bf16_f32 v203, v143, v142
    ds_write_b128 v30, v[200:203] offset:1024
    s_waitcnt lgkmcnt(7)
    v_cvt_pk_bf16_f32 v204, v145, v144
    v_cvt_pk_bf16_f32 v205, v146, v145
    v_cvt_pk_bf16_f32 v206, v147, v146
    v_cvt_pk_bf16_f32 v207, v148, v147
    ds_write_b128 v30, v[204:207] offset:2048
    s_waitcnt lgkmcnt(3)
    v_cvt_pk_bf16_f32 v208, v150, v149
    v_cvt_pk_bf16_f32 v209, v151, v150
    v_cvt_pk_bf16_f32 v210, v152, v151
    v_cvt_pk_bf16_f32 v211, v153, v152
    ds_write_b128 v30, v[208:211] offset:3072
    s_cmp_eq_u64 s[70:71], 0
    s_cbranch_scc1 gated_mix__ssm_conv_s5__ssm_conv_s4__prompt_kernel_F1E35
    s_mov_b32 s11, 1048576
gated_mix__ssm_conv_s5__ssm_conv_s4__prompt_kernel_F133:
    s_waitcnt vmcnt(0)
    v_cmp_ne_u32 vcc, s10, v10
    s_cbranch_vccz gated_mix__ssm_conv_s5__ssm_conv_s4__prompt_kernel_F1D34
    s_sub_u32 s11, s11, 1
    s_cmp_eq_u32 s11, 0
    s_cbranch_scc1 gated_mix__ssm_conv_s5__ssm_conv_s4__prompt_kernel_F1D34
    global_load_dword v10, v16, s[58:59] sc1
    s_branch gated_mix__ssm_conv_s5__ssm_conv_s4__prompt_kernel_F133
gated_mix__ssm_conv_s5__ssm_conv_s4__prompt_kernel_F1D34:
    global_load_dwordx4 v[64:67], v8, s[58:59] sc1
    global_load_dwordx4 v[68:71], v8, s[58:59] offset:1024 sc1
gated_mix__ssm_conv_s5__ssm_conv_s4__prompt_kernel_F1E35:
    s_waitcnt vmcnt(1)
    ds_write_b128 v9, v[64:67] offset:512
    s_waitcnt vmcnt(0)
    ds_write_b128 v9, v[68:71] offset:1536
    s_waitcnt lgkmcnt(0)
    v_mov_b32 v4, 2
    ds_write_b32 v14, v4
    s_mov_b32 s11, 1048576
gated_mix__ssm_conv_s5__ssm_conv_s4__prompt_kernel_PW36:
    ds_read_b32 v4, v15
    s_waitcnt lgkmcnt(0)
    s_sub_u32 s11, s11, 1
    v_readfirstlane_b32 s14, v4
    s_cmp_eq_u32 s11, 0
    s_cbranch_scc1 gated_mix__ssm_conv_s5__ssm_conv_s4__prompt_kernel_PD37
    s_cmp_lt_u32 s14, 2
    s_cbranch_scc1 gated_mix__ssm_conv_s5__ssm_conv_s4__prompt_kernel_PW36
gated_mix__ssm_conv_s5__ssm_conv_s4__prompt_kernel_PD37:
    s_setprio 0
    ds_read_b128 v[128:131], v27 offset:192
    ds_read2_b32 v[64:65], v19 offset0:6 offset1:4
    ds_read2_b32 v[66:67], v19 offset0:2 offset1:0
    ds_read_b128 v[132:135], v27 offset:704
    ds_read2_b32 v[68:69], v20 offset0:6 offset1:4
    ds_read2_b32 v[70:71], v20 offset0:2 offset1:0
    ds_read_b128 v[136:139], v27 offset:1216
    ds_read2_b32 v[72:73], v21 offset0:6 offset1:4
    ds_read2_b32 v[74:75], v21 offset0:2 offset1:0
    ds_read_b128 v[140:143], v27 offset:1728
    ds_read2_b32 v[76:77], v22 offset0:6 offset1:4
    ds_read2_b32 v[78:79], v22 offset0:2 offset1:0
    ds_read_b128 v[144:147], v27 offset:2240
    ds_read2_b32 v[80:81], v23 offset0:6 offset1:4
    ds_read2_b32 v[82:83], v23 offset0:2 offset1:0
    ds_read_b128 v[148:151], v27 offset:2752
    ds_read2_b32 v[84:85], v24 offset0:6 offset1:4
    ds_read2_b32 v[86:87], v24 offset0:2 offset1:0
    ds_read_b128 v[152:155], v27 offset:3264
    ds_read2_b32 v[88:89], v25 offset0:6 offset1:4
    ds_read2_b32 v[90:91], v25 offset0:2 offset1:0
    ds_read_b128 v[156:159], v27 offset:3776
    ds_read2_b32 v[92:93], v26 offset0:6 offset1:4
    ds_read2_b32 v[94:95], v26 offset0:2 offset1:0
    s_waitcnt lgkmcnt(0)
    v_mfma_f32_16x16x32_bf16 v[32:35], v[64:67], v[128:131], 0
    ds_read_b128 v[160:163], v27 offset:128
    v_lshrrev_b32 v4, 4, v1
    v_mfma_f32_16x16x32_bf16 v[36:39], v[68:71], v[128:131], 0
    ds_read2_b32 v[96:97], v19 offset0:38 offset1:36
    v_and_b32 v192, 15, v1
    v_mfma_f32_16x16x32_bf16 v[40:43], v[72:75], v[128:131], 0
    ds_read2_b32 v[98:99], v19 offset0:34 offset1:32
    v_xor_b32 v192, v192, v4
    v_mfma_f32_16x16x32_bf16 v[44:47], v[76:79], v[128:131], 0
    ds_read_b128 v[164:167], v27 offset:640
    v_lshlrev_b32 v192, 4, v192
    v_mfma_f32_16x16x32_bf16 v[48:51], v[80:83], v[128:131], 0
    ds_read2_b32 v[100:101], v20 offset0:38 offset1:36
    v_lshl_add_u32 v192, v4, 10, v192
    v_mfma_f32_16x16x32_bf16 v[52:55], v[84:87], v[128:131], 0
    ds_read2_b32 v[102:103], v20 offset0:34 offset1:32
    v_xor_b32 v193, 64, v192
    v_mfma_f32_16x16x32_bf16 v[56:59], v[88:91], v[128:131], 0
    ds_read_b128 v[168:171], v27 offset:1152
    v_xor_b32 v194, 128, v192
    v_mfma_f32_16x16x32_bf16 v[60:63], v[92:95], v[128:131], 0
    ds_read2_b32 v[104:105], v21 offset0:38 offset1:36
    v_xor_b32 v195, 192, v192
    v_mfma_f32_16x16x32_bf16 v[36:39], v[64:67], v[132:135], v[36:39]
    ds_read2_b32 v[106:107], v21 offset0:34 offset1:32
    s_mov_b32 s68, s26
    v_mfma_f32_16x16x32_bf16 v[40:43], v[68:71], v[132:135], v[40:43]
    ds_read_b128 v[172:175], v27 offset:1664
    s_and_b32 s69, s27, 0xffff
    v_mfma_f32_16x16x32_bf16 v[44:47], v[72:75], v[132:135], v[44:47]
    ds_read2_b32 v[108:109], v22 offset0:38 offset1:36
    s_mov_b32 s70, 524288
    v_mfma_f32_16x16x32_bf16 v[48:51], v[76:79], v[132:135], v[48:51]
    ds_read2_b32 v[110:111], v22 offset0:34 offset1:32
    s_mov_b32 s71, 0x20000
    v_mfma_f32_16x16x32_bf16 v[52:55], v[80:83], v[132:135], v[52:55]
    ds_read_b128 v[176:179], v27 offset:2176
    s_mov_b32 s72, s28
    v_mfma_f32_16x16x32_bf16 v[56:59], v[84:87], v[132:135], v[56:59]
    ds_read2_b32 v[112:113], v23 offset0:38 offset1:36
    s_and_b32 s73, s29, 0xffff
    v_mfma_f32_16x16x32_bf16 v[60:63], v[88:91], v[132:135], v[60:63]
    ds_read2_b32 v[114:115], v23 offset0:34 offset1:32
    s_mov_b32 s74, 524288
    v_mfma_f32_16x16x32_bf16 v[40:43], v[64:67], v[136:139], v[40:43]
    ds_read_b128 v[180:183], v27 offset:2688
    s_mov_b32 s75, 0x20000
    v_mfma_f32_16x16x32_bf16 v[44:47], v[68:71], v[136:139], v[44:47]
    ds_read2_b32 v[116:117], v24 offset0:38 offset1:36
    s_lshl_b32 s76, s9, 16
    v_mfma_f32_16x16x32_bf16 v[48:51], v[72:75], v[136:139], v[48:51]
    ds_read2_b32 v[118:119], v24 offset0:34 offset1:32
    s_lshl_b32 s77, s60, 14
    v_mfma_f32_16x16x32_bf16 v[52:55], v[76:79], v[136:139], v[52:55]
    ds_read_b128 v[184:187], v27 offset:3200
    s_add_u32 s76, s76, s77
    v_mfma_f32_16x16x32_bf16 v[56:59], v[80:83], v[136:139], v[56:59]
    ds_read2_b32 v[120:121], v25 offset0:38 offset1:36
    s_lshl_b32 s77, s60, 12
    v_mfma_f32_16x16x32_bf16 v[60:63], v[84:87], v[136:139], v[60:63]
    ds_read2_b32 v[122:123], v25 offset0:34 offset1:32
    v_mov_b32 v196, 153088
    v_mfma_f32_16x16x32_bf16 v[44:47], v[64:67], v[140:143], v[44:47]
    ds_read_b128 v[188:191], v27 offset:3712
    s_cmp_eq_u32 s62, 0
    v_mfma_f32_16x16x32_bf16 v[48:51], v[68:71], v[140:143], v[48:51]
    ds_read2_b32 v[124:125], v26 offset0:38 offset1:36
    s_cselect_b32 s36, s68, s72
    v_mfma_f32_16x16x32_bf16 v[52:55], v[72:75], v[140:143], v[52:55]
    ds_read2_b32 v[126:127], v26 offset0:34 offset1:32
    s_cselect_b32 s37, s69, s73
    v_mfma_f32_16x16x32_bf16 v[56:59], v[76:79], v[140:143], v[56:59]
    s_mov_b32 s38, 524288
    v_mfma_f32_16x16x32_bf16 v[60:63], v[80:83], v[140:143], v[60:63]
    s_mov_b32 s39, 0x20000
    v_mfma_f32_16x16x32_bf16 v[48:51], v[64:67], v[144:147], v[48:51]
    s_lshl_b32 s40, s9, 16
    v_mfma_f32_16x16x32_bf16 v[52:55], v[68:71], v[144:147], v[52:55]
    s_lshl_b32 s41, s61, 8
    v_mfma_f32_16x16x32_bf16 v[56:59], v[72:75], v[144:147], v[56:59]
    s_add_u32 s40, s40, s41
    v_mfma_f32_16x16x32_bf16 v[60:63], v[76:79], v[144:147], v[60:63]
    s_lshl_b32 s41, s60, 14
    v_mfma_f32_16x16x32_bf16 v[52:55], v[64:67], v[148:151], v[52:55]
    v_mfma_f32_16x16x32_bf16 v[56:59], v[68:71], v[148:151], v[56:59]
    v_mfma_f32_16x16x32_bf16 v[60:63], v[72:75], v[148:151], v[60:63]
    v_mfma_f32_16x16x32_bf16 v[56:59], v[64:67], v[152:155], v[56:59]
    v_mfma_f32_16x16x32_bf16 v[60:63], v[68:71], v[152:155], v[60:63]
    v_mfma_f32_16x16x32_bf16 v[60:63], v[64:67], v[156:159], v[60:63]
    s_waitcnt lgkmcnt(0)
    v_mfma_f32_16x16x32_bf16 v[32:35], v[96:99], v[160:163], v[32:35]
    ds_read_b128 v[128:131], v27 offset:64
    v_mfma_f32_16x16x32_bf16 v[36:39], v[100:103], v[160:163], v[36:39]
    ds_read2_b32 v[64:65], v19 offset0:70 offset1:68
    v_mfma_f32_16x16x32_bf16 v[40:43], v[104:107], v[160:163], v[40:43]
    ds_read2_b32 v[66:67], v19 offset0:66 offset1:64
    v_mfma_f32_16x16x32_bf16 v[44:47], v[108:111], v[160:163], v[44:47]
    ds_read_b128 v[132:135], v27 offset:576
    v_mfma_f32_16x16x32_bf16 v[48:51], v[112:115], v[160:163], v[48:51]
    ds_read2_b32 v[68:69], v20 offset0:70 offset1:68
    v_mfma_f32_16x16x32_bf16 v[52:55], v[116:119], v[160:163], v[52:55]
    ds_read2_b32 v[70:71], v20 offset0:66 offset1:64
    v_mfma_f32_16x16x32_bf16 v[56:59], v[120:123], v[160:163], v[56:59]
    ds_read_b128 v[136:139], v27 offset:1088
    v_mfma_f32_16x16x32_bf16 v[60:63], v[124:127], v[160:163], v[60:63]
    ds_read2_b32 v[72:73], v21 offset0:70 offset1:68
    v_mfma_f32_16x16x32_bf16 v[36:39], v[96:99], v[164:167], v[36:39]
    ds_read2_b32 v[74:75], v21 offset0:66 offset1:64
    v_mfma_f32_16x16x32_bf16 v[40:43], v[100:103], v[164:167], v[40:43]
    ds_read_b128 v[140:143], v27 offset:1600
    v_mfma_f32_16x16x32_bf16 v[44:47], v[104:107], v[164:167], v[44:47]
    ds_read2_b32 v[76:77], v22 offset0:70 offset1:68
    v_mfma_f32_16x16x32_bf16 v[48:51], v[108:111], v[164:167], v[48:51]
    ds_read2_b32 v[78:79], v22 offset0:66 offset1:64
    v_mfma_f32_16x16x32_bf16 v[52:55], v[112:115], v[164:167], v[52:55]
    ds_read_b128 v[144:147], v27 offset:2112
    v_mfma_f32_16x16x32_bf16 v[56:59], v[116:119], v[164:167], v[56:59]
    ds_read2_b32 v[80:81], v23 offset0:70 offset1:68
    v_mfma_f32_16x16x32_bf16 v[60:63], v[120:123], v[164:167], v[60:63]
    ds_read2_b32 v[82:83], v23 offset0:66 offset1:64
    v_mfma_f32_16x16x32_bf16 v[40:43], v[96:99], v[168:171], v[40:43]
    ds_read_b128 v[148:151], v27 offset:2624
    v_mfma_f32_16x16x32_bf16 v[44:47], v[100:103], v[168:171], v[44:47]
    ds_read2_b32 v[84:85], v24 offset0:70 offset1:68
    v_mfma_f32_16x16x32_bf16 v[48:51], v[104:107], v[168:171], v[48:51]
    ds_read2_b32 v[86:87], v24 offset0:66 offset1:64
    v_mfma_f32_16x16x32_bf16 v[52:55], v[108:111], v[168:171], v[52:55]
    ds_read_b128 v[152:155], v27 offset:3136
    v_mfma_f32_16x16x32_bf16 v[56:59], v[112:115], v[168:171], v[56:59]
    ds_read2_b32 v[88:89], v25 offset0:70 offset1:68
    v_mfma_f32_16x16x32_bf16 v[60:63], v[116:119], v[168:171], v[60:63]
    ds_read2_b32 v[90:91], v25 offset0:66 offset1:64
    v_mfma_f32_16x16x32_bf16 v[44:47], v[96:99], v[172:175], v[44:47]
    ds_read_b128 v[156:159], v27 offset:3648
    v_mfma_f32_16x16x32_bf16 v[48:51], v[100:103], v[172:175], v[48:51]
    ds_read2_b32 v[92:93], v26 offset0:70 offset1:68
    v_mfma_f32_16x16x32_bf16 v[52:55], v[104:107], v[172:175], v[52:55]
    ds_read2_b32 v[94:95], v26 offset0:66 offset1:64
    v_mfma_f32_16x16x32_bf16 v[56:59], v[108:111], v[172:175], v[56:59]
    v_mfma_f32_16x16x32_bf16 v[60:63], v[112:115], v[172:175], v[60:63]
    v_mfma_f32_16x16x32_bf16 v[48:51], v[96:99], v[176:179], v[48:51]
    v_mfma_f32_16x16x32_bf16 v[52:55], v[100:103], v[176:179], v[52:55]
    v_mfma_f32_16x16x32_bf16 v[56:59], v[104:107], v[176:179], v[56:59]
    v_mfma_f32_16x16x32_bf16 v[60:63], v[108:111], v[176:179], v[60:63]
    v_mfma_f32_16x16x32_bf16 v[52:55], v[96:99], v[180:183], v[52:55]
    v_mfma_f32_16x16x32_bf16 v[56:59], v[100:103], v[180:183], v[56:59]
    v_mfma_f32_16x16x32_bf16 v[60:63], v[104:107], v[180:183], v[60:63]
    v_mfma_f32_16x16x32_bf16 v[56:59], v[96:99], v[184:187], v[56:59]
    v_mfma_f32_16x16x32_bf16 v[60:63], v[100:103], v[184:187], v[60:63]
    v_mfma_f32_16x16x32_bf16 v[60:63], v[96:99], v[188:191], v[60:63]
    s_waitcnt lgkmcnt(0)
    v_mfma_f32_16x16x32_bf16 v[32:35], v[64:67], v[128:131], v[32:35]
    ds_read_b128 v[160:163], v27 offset:0
    v_mfma_f32_16x16x32_bf16 v[36:39], v[68:71], v[128:131], v[36:39]
    ds_read2_b32 v[96:97], v19 offset0:102 offset1:100
    v_mfma_f32_16x16x32_bf16 v[40:43], v[72:75], v[128:131], v[40:43]
    ds_read2_b32 v[98:99], v19 offset0:98 offset1:96
    v_mfma_f32_16x16x32_bf16 v[44:47], v[76:79], v[128:131], v[44:47]
    ds_read_b128 v[164:167], v27 offset:512
    v_mfma_f32_16x16x32_bf16 v[48:51], v[80:83], v[128:131], v[48:51]
    ds_read2_b32 v[100:101], v20 offset0:102 offset1:100
    v_mfma_f32_16x16x32_bf16 v[52:55], v[84:87], v[128:131], v[52:55]
    ds_read2_b32 v[102:103], v20 offset0:98 offset1:96
    v_mfma_f32_16x16x32_bf16 v[56:59], v[88:91], v[128:131], v[56:59]
    ds_read_b128 v[168:171], v27 offset:1024
    v_mfma_f32_16x16x32_bf16 v[60:63], v[92:95], v[128:131], v[60:63]
    ds_read2_b32 v[104:105], v21 offset0:102 offset1:100
    v_mfma_f32_16x16x32_bf16 v[36:39], v[64:67], v[132:135], v[36:39]
    ds_read2_b32 v[106:107], v21 offset0:98 offset1:96
    v_mfma_f32_16x16x32_bf16 v[40:43], v[68:71], v[132:135], v[40:43]
    ds_read_b128 v[172:175], v27 offset:1536
    v_mfma_f32_16x16x32_bf16 v[44:47], v[72:75], v[132:135], v[44:47]
    ds_read2_b32 v[108:109], v22 offset0:102 offset1:100
    v_mfma_f32_16x16x32_bf16 v[48:51], v[76:79], v[132:135], v[48:51]
    ds_read2_b32 v[110:111], v22 offset0:98 offset1:96
    v_mfma_f32_16x16x32_bf16 v[52:55], v[80:83], v[132:135], v[52:55]
    ds_read_b128 v[176:179], v27 offset:2048
    v_mfma_f32_16x16x32_bf16 v[56:59], v[84:87], v[132:135], v[56:59]
    ds_read2_b32 v[112:113], v23 offset0:102 offset1:100
    v_mfma_f32_16x16x32_bf16 v[60:63], v[88:91], v[132:135], v[60:63]
    ds_read2_b32 v[114:115], v23 offset0:98 offset1:96
    v_mfma_f32_16x16x32_bf16 v[40:43], v[64:67], v[136:139], v[40:43]
    ds_read_b128 v[180:183], v27 offset:2560
    v_mfma_f32_16x16x32_bf16 v[44:47], v[68:71], v[136:139], v[44:47]
    ds_read2_b32 v[116:117], v24 offset0:102 offset1:100
    v_mfma_f32_16x16x32_bf16 v[48:51], v[72:75], v[136:139], v[48:51]
    ds_read2_b32 v[118:119], v24 offset0:98 offset1:96
    v_mfma_f32_16x16x32_bf16 v[52:55], v[76:79], v[136:139], v[52:55]
    ds_read_b128 v[184:187], v27 offset:3072
    v_mfma_f32_16x16x32_bf16 v[56:59], v[80:83], v[136:139], v[56:59]
    ds_read2_b32 v[120:121], v25 offset0:102 offset1:100
    v_mfma_f32_16x16x32_bf16 v[60:63], v[84:87], v[136:139], v[60:63]
    ds_read2_b32 v[122:123], v25 offset0:98 offset1:96
    v_mfma_f32_16x16x32_bf16 v[44:47], v[64:67], v[140:143], v[44:47]
    ds_read_b128 v[188:191], v27 offset:3584
    v_mfma_f32_16x16x32_bf16 v[48:51], v[68:71], v[140:143], v[48:51]
    ds_read2_b32 v[124:125], v26 offset0:102 offset1:100
    v_mfma_f32_16x16x32_bf16 v[52:55], v[72:75], v[140:143], v[52:55]
    ds_read2_b32 v[126:127], v26 offset0:98 offset1:96
    v_mfma_f32_16x16x32_bf16 v[56:59], v[76:79], v[140:143], v[56:59]
    v_mfma_f32_16x16x32_bf16 v[60:63], v[80:83], v[140:143], v[60:63]
    v_mfma_f32_16x16x32_bf16 v[48:51], v[64:67], v[144:147], v[48:51]
    v_mfma_f32_16x16x32_bf16 v[52:55], v[68:71], v[144:147], v[52:55]
    v_mfma_f32_16x16x32_bf16 v[56:59], v[72:75], v[144:147], v[56:59]
    v_mfma_f32_16x16x32_bf16 v[60:63], v[76:79], v[144:147], v[60:63]
    v_mfma_f32_16x16x32_bf16 v[52:55], v[64:67], v[148:151], v[52:55]
    v_mfma_f32_16x16x32_bf16 v[56:59], v[68:71], v[148:151], v[56:59]
    v_mfma_f32_16x16x32_bf16 v[60:63], v[72:75], v[148:151], v[60:63]
    v_mfma_f32_16x16x32_bf16 v[56:59], v[64:67], v[152:155], v[56:59]
    v_mfma_f32_16x16x32_bf16 v[60:63], v[68:71], v[152:155], v[60:63]
    v_mfma_f32_16x16x32_bf16 v[60:63], v[64:67], v[156:159], v[60:63]
    s_waitcnt lgkmcnt(0)
    v_mfma_f32_16x16x32_bf16 v[32:35], v[96:99], v[160:163], v[32:35]
    v_mfma_f32_16x16x32_bf16 v[36:39], v[100:103], v[160:163], v[36:39]
    v_mfma_f32_16x16x32_bf16 v[40:43], v[104:107], v[160:163], v[40:43]
    v_mfma_f32_16x16x32_bf16 v[44:47], v[108:111], v[160:163], v[44:47]
    v_mfma_f32_16x16x32_bf16 v[48:51], v[112:115], v[160:163], v[48:51]
    v_mfma_f32_16x16x32_bf16 v[52:55], v[116:119], v[160:163], v[52:55]
    v_mfma_f32_16x16x32_bf16 v[56:59], v[120:123], v[160:163], v[56:59]
    v_mfma_f32_16x16x32_bf16 v[60:63], v[124:127], v[160:163], v[60:63]
    v_mfma_f32_16x16x32_bf16 v[36:39], v[96:99], v[164:167], v[36:39]
    v_mfma_f32_16x16x32_bf16 v[40:43], v[100:103], v[164:167], v[40:43]
    v_mfma_f32_16x16x32_bf16 v[44:47], v[104:107], v[164:167], v[44:47]
    v_mfma_f32_16x16x32_bf16 v[48:51], v[108:111], v[164:167], v[48:51]
    v_mfma_f32_16x16x32_bf16 v[52:55], v[112:115], v[164:167], v[52:55]
    v_mfma_f32_16x16x32_bf16 v[56:59], v[116:119], v[164:167], v[56:59]
    v_mfma_f32_16x16x32_bf16 v[60:63], v[120:123], v[164:167], v[60:63]
    v_mfma_f32_16x16x32_bf16 v[40:43], v[96:99], v[168:171], v[40:43]
    v_mfma_f32_16x16x32_bf16 v[44:47], v[100:103], v[168:171], v[44:47]
    v_mfma_f32_16x16x32_bf16 v[48:51], v[104:107], v[168:171], v[48:51]
    v_mfma_f32_16x16x32_bf16 v[52:55], v[108:111], v[168:171], v[52:55]
    v_mfma_f32_16x16x32_bf16 v[56:59], v[112:115], v[168:171], v[56:59]
    v_mfma_f32_16x16x32_bf16 v[60:63], v[116:119], v[168:171], v[60:63]
    v_mfma_f32_16x16x32_bf16 v[44:47], v[96:99], v[172:175], v[44:47]
    v_mfma_f32_16x16x32_bf16 v[48:51], v[100:103], v[172:175], v[48:51]
    v_mfma_f32_16x16x32_bf16 v[52:55], v[104:107], v[172:175], v[52:55]
    v_mfma_f32_16x16x32_bf16 v[56:59], v[108:111], v[172:175], v[56:59]
    v_mfma_f32_16x16x32_bf16 v[60:63], v[112:115], v[172:175], v[60:63]
    v_mfma_f32_16x16x32_bf16 v[48:51], v[96:99], v[176:179], v[48:51]
    v_mfma_f32_16x16x32_bf16 v[52:55], v[100:103], v[176:179], v[52:55]
    v_mfma_f32_16x16x32_bf16 v[56:59], v[104:107], v[176:179], v[56:59]
    v_mfma_f32_16x16x32_bf16 v[60:63], v[108:111], v[176:179], v[60:63]
    v_mfma_f32_16x16x32_bf16 v[52:55], v[96:99], v[180:183], v[52:55]
    v_mfma_f32_16x16x32_bf16 v[56:59], v[100:103], v[180:183], v[56:59]
    v_mfma_f32_16x16x32_bf16 v[60:63], v[104:107], v[180:183], v[60:63]
    v_mfma_f32_16x16x32_bf16 v[56:59], v[96:99], v[184:187], v[56:59]
    v_mfma_f32_16x16x32_bf16 v[60:63], v[100:103], v[184:187], v[60:63]
    v_mfma_f32_16x16x32_bf16 v[60:63], v[96:99], v[188:191], v[60:63]
    v_mov_b32 v4, 3
    ds_write_b32 v14, v4
    s_mov_b32 s11, 1048576
gated_mix__ssm_conv_s5__ssm_conv_s4__prompt_kernel_PW38:
    ds_read_b32 v4, v15
    s_waitcnt lgkmcnt(0)
    s_sub_u32 s11, s11, 1
    v_readfirstlane_b32 s14, v4
    s_cmp_eq_u32 s11, 0
    s_cbranch_scc1 gated_mix__ssm_conv_s5__ssm_conv_s4__prompt_kernel_PD39
    s_cmp_lt_u32 s14, 3
    s_cbranch_scc1 gated_mix__ssm_conv_s5__ssm_conv_s4__prompt_kernel_PW38
gated_mix__ssm_conv_s5__ssm_conv_s4__prompt_kernel_PD39:
    s_cmp_lg_u32 s62, 0
    s_cbranch_scc1 gated_mix__ssm_conv_s5__ssm_conv_s4__prompt_kernel_RH40
    ds_write_b128 v29, v[48:51] offset:0
    ds_write_b128 v29, v[52:55] offset:1024
    ds_write_b128 v29, v[56:59] offset:2048
    ds_write_b128 v29, v[60:63] offset:3072
    v_mov_b32 v4, 4
    ds_write_b32 v14, v4
    s_mov_b32 s11, 1048576
gated_mix__ssm_conv_s5__ssm_conv_s4__prompt_kernel_PW42:
    ds_read_b32 v4, v15
    s_waitcnt lgkmcnt(0)
    s_sub_u32 s11, s11, 1
    v_readfirstlane_b32 s14, v4
    s_cmp_eq_u32 s11, 0
    s_cbranch_scc1 gated_mix__ssm_conv_s5__ssm_conv_s4__prompt_kernel_PD43
    s_cmp_lt_u32 s14, 4
    s_cbranch_scc1 gated_mix__ssm_conv_s5__ssm_conv_s4__prompt_kernel_PW42
gated_mix__ssm_conv_s5__ssm_conv_s4__prompt_kernel_PD43:
    ds_read_b128 v[64:67], v30 offset:0
    ds_read_b128 v[68:71], v30 offset:1024
    ds_read_b128 v[72:75], v30 offset:2048
    ds_read_b128 v[76:79], v30 offset:3072
    s_waitcnt lgkmcnt(3)
    v_add_f32 v64, v64, v32
    v_add_f32 v65, v65, v33
    v_add_f32 v66, v66, v34
    v_add_f32 v67, v67, v35
    s_waitcnt lgkmcnt(2)
    v_add_f32 v68, v68, v36
    v_add_f32 v69, v69, v37
    v_add_f32 v70, v70, v38
    v_add_f32 v71, v71, v39
    s_waitcnt lgkmcnt(1)
    v_add_f32 v72, v72, v40
    v_add_f32 v73, v73, v41
    v_add_f32 v74, v74, v42
    v_add_f32 v75, v75, v43
    s_waitcnt lgkmcnt(0)
    v_add_f32 v76, v76, v44
    v_add_f32 v77, v77, v45
    v_add_f32 v78, v78, v46
    v_add_f32 v79, v79, v47
    s_branch gated_mix__ssm_conv_s5__ssm_conv_s4__prompt_kernel_RE41
gated_mix__ssm_conv_s5__ssm_conv_s4__prompt_kernel_RH40:
    ds_write_b128 v29, v[32:35] offset:0
    ds_write_b128 v29, v[36:39] offset:1024
    ds_write_b128 v29, v[40:43] offset:2048
    ds_write_b128 v29, v[44:47] offset:3072
    v_mov_b32 v4, 4
    ds_write_b32 v14, v4
    s_mov_b32 s11, 1048576
gated_mix__ssm_conv_s5__ssm_conv_s4__prompt_kernel_PW44:
    ds_read_b32 v4, v15
    s_waitcnt lgkmcnt(0)
    s_sub_u32 s11, s11, 1
    v_readfirstlane_b32 s14, v4
    s_cmp_eq_u32 s11, 0
    s_cbranch_scc1 gated_mix__ssm_conv_s5__ssm_conv_s4__prompt_kernel_PD45
    s_cmp_lt_u32 s14, 4
    s_cbranch_scc1 gated_mix__ssm_conv_s5__ssm_conv_s4__prompt_kernel_PW44
gated_mix__ssm_conv_s5__ssm_conv_s4__prompt_kernel_PD45:
    ds_read_b128 v[64:67], v30 offset:0
    ds_read_b128 v[68:71], v30 offset:1024
    ds_read_b128 v[72:75], v30 offset:2048
    ds_read_b128 v[76:79], v30 offset:3072
    s_waitcnt lgkmcnt(3)
    v_add_f32 v64, v64, v48
    v_add_f32 v65, v65, v49
    v_add_f32 v66, v66, v50
    v_add_f32 v67, v67, v51
    s_waitcnt lgkmcnt(2)
    v_add_f32 v68, v68, v52
    v_add_f32 v69, v69, v53
    v_add_f32 v70, v70, v54
    v_add_f32 v71, v71, v55
    s_waitcnt lgkmcnt(1)
    v_add_f32 v72, v72, v56
    v_add_f32 v73, v73, v57
    v_add_f32 v74, v74, v58
    v_add_f32 v75, v75, v59
    s_waitcnt lgkmcnt(0)
    v_add_f32 v76, v76, v60
    v_add_f32 v77, v77, v61
    v_add_f32 v78, v78, v62
    v_add_f32 v79, v79, v63
gated_mix__ssm_conv_s5__ssm_conv_s4__prompt_kernel_RE41:
    v_cvt_pk_bf16_f32 v80, v64, v65
    v_cvt_pk_bf16_f32 v81, v66, v67
    v_cvt_pk_bf16_f32 v82, v68, v69
    v_cvt_pk_bf16_f32 v83, v70, v71
    v_cvt_pk_bf16_f32 v84, v72, v73
    v_cvt_pk_bf16_f32 v85, v74, v75
    v_cvt_pk_bf16_f32 v86, v76, v77
    v_cvt_pk_bf16_f32 v87, v78, v79
    v_permlane16_swap_b32 v80, v82
    v_permlane16_swap_b32 v81, v83
    v_permlane16_swap_b32 v84, v86
    v_permlane16_swap_b32 v85, v87
    v_mov_b32 v4, 5
    ds_write_b32 v14, v4
    global_store_dwordx4 v28, v[80:83], s[58:59] offset:0 sc1
    global_store_dwordx4 v28, v[84:87], s[58:59] offset:1024 sc1
    s_lshl_b32 s12, s62, 9
    s_add_u32 s12, s12, s63
    s_lshl_b32 s12, s12, 2
    s_add_u32 s12, s12, 8540160
    v_mov_b32 v4, s12
    v_mov_b32 v5, s10
    s_mov_b32 s11, 1048576
gated_mix__ssm_conv_s5__ssm_conv_s4__prompt_kernel_PW46:
    ds_read_b128 v[8:11], v196 offset:0
    s_waitcnt lgkmcnt(0)
    v_min3_u32 v8, v8, v9, v10
    v_min_u32 v8, v8, v11
    s_sub_u32 s11, s11, 1
    v_readfirstlane_b32 s14, v8
    s_cmp_eq_u32 s11, 0
    s_cbranch_scc1 gated_mix__ssm_conv_s5__ssm_conv_s4__prompt_kernel_PD47
    s_cmp_lt_u32 s14, 6
    s_cbranch_scc1 gated_mix__ssm_conv_s5__ssm_conv_s4__prompt_kernel_PW46
gated_mix__ssm_conv_s5__ssm_conv_s4__prompt_kernel_PD47:
    s_add_u32 m0, s77, 49152
    s_add_u32 s15, s76, 256
    buffer_load_dwordx4 v192, s[72:75], s15 offen lds
    s_add_u32 m0, s77, 50176
    s_add_u32 s15, s76, 4352
    buffer_load_dwordx4 v193, s[72:75], s15 offen lds
    s_add_u32 m0, s77, 51200
    s_add_u32 s15, s76, 8448
    buffer_load_dwordx4 v194, s[72:75], s15 offen lds
    s_add_u32 m0, s77, 52224
    s_add_u32 s15, s76, 12544
    buffer_load_dwordx4 v195, s[72:75], s15 offen lds
    s_add_u32 m0, s41, 80896
    s_add_u32 s15, s40, 61952
    buffer_load_dwordx4 v195, s[36:39], s15 offen lds
    s_waitcnt vmcnt(5)
    s_mov_b64 exec, 1
    global_store_dword v4, v5, s[58:59] sc1
    s_mov_b64 exec, -1
    v_mov_b32 v2, v14
gated_mix__ssm_conv_s5__ssm_conv_s4__prompt_kernel_P2:
    s_and_b32 s61, s3, 3
    s_lshr_b32 s60, s3, 2
    s_and_b32 s62, s61, 1
    s_lshr_b32 s63, s61, 1
    s_lshl_b32 s12, s8, 2
    s_lshl_b32 s13, s60, 1
    s_add_u32 s64, s12, s13
    s_add_u32 s12, s64, s62
    s_lshl_b32 s12, s12, 4
    s_lshl_b32 s13, s9, 6
    s_lshl_b32 s14, s63, 5
    s_add_u32 s13, s13, s14
    v_and_b32 v32, 15, v1
    v_lshrrev_b32 v33, 4, v1
    v_and_b32 v34, 1, v1
    v_bfe_u32 v35, v1, 1, 3
    v_lshl_add_u32 v34, v34, 3, v35
    v_add_u32 v34, s12, v34
    v_lshl_add_u32 v35, v33, 2, s13
    v_lshlrev_b32 v36, 1, v35
    v_lshl_add_u32 v37, v34, 10, v36
    v_lshlrev_b32 v8, 1, v37
    global_load_dwordx2 v[40:41], v37, s[16:17] offset:0
    global_load_dwordx2 v[44:45], v36, s[32:33] offset:0
    global_load_dwordx2 v[48:49], v36, s[50:51] offset:0
    global_load_dwordx2 v[42:43], v37, s[16:17] offset:32
    global_load_dwordx2 v[46:47], v36, s[32:33] offset:32
    global_load_dwordx2 v[50:51], v36, s[50:51] offset:32
    v_and_b32 v11, 63, v34
    v_lshlrev_b32 v11, 1, v11
    v_lshlrev_b32 v63, 5, v33
    v_xor_b32 v11, v11, v63
    v_and_b32 v63, 63, v35
    v_lshl_add_u32 v11, v63, 7, v11
    v_add_u32 v11, 153120, v11
    v_lshrrev_b32 v60, 1, v34
    v_lshlrev_b32 v60, 4, v60
    v_add_u32 v60, 8523776, v60
    s_lshr_b32 s14, s8, 4
    s_lshl_b32 s14, s14, 11
    s_lshl_b32 s15, s9, 8
    s_add_u32 s14, s14, s15
    s_add_u32 s14, s14, 8540160
    v_lshl_add_u32 v62, v1, 2, s14
    s_lshl_b32 s14, s8, 9
    s_add_u32 s14, s14, 8523784
    v_and_b32 v61, 31, v1
    v_lshl_add_u32 v61, v61, 4, s14
    s_cmp_eq_u32 s3, 7
    s_cselect_b64 vcc, -1, 0
    v_cndmask_b32 v62, v62, v61, vcc
    v_lshrrev_b32 v63, 5, v1
    v_lshlrev_b32 v63, 1, v63
    v_xor_b32 v63, v1, v63
    v_and_b32 v63, 7, v63
    v_lshlrev_b32 v63, 4, v63
    v_lshrrev_b32 v61, 3, v1
    v_lshl_add_u32 v63, v61, 12, v63
    v_xor_b32 v61, 64, v63
    s_lshl_b32 s68, s9, 18
    s_lshl_b32 s14, s8, 7
    s_add_u32 s68, s68, s14
    s_lshl_b32 s14, s64, 15
    s_lshl_b32 s13, s61, 13
    s_add_u32 s14, s14, s13
    s_add_u32 s14, s14, 2097152
    v_lshl_add_u32 v56, v1, 4, s14
    s_and_b32 s13, 0, 3
    s_lshl_b32 s14, s13, 11
    v_xor_b32 v56, s14, v56
    s_lshl_b32 s13, s13, 6
    v_xor_b32 v34, v32, v33
    v_lshlrev_b32 v34, 4, v34
    v_lshl_add_u32 v34, v32, 8, v34
    s_lshl_b32 s12, s61, 15
    v_add_u32 v52, s12, v34
    v_xor_b32 v52, s13, v52
    v_xor_b32 v53, 64, v52
    v_xor_b32 v54, 128, v52
    v_xor_b32 v55, 192, v52
    s_mov_b32 s64, s58
    s_and_b32 s65, s59, 0xffff
    s_mov_b32 s66, 9437184
    s_mov_b32 s67, 0x20000
    v_mov_b32 v12, 0
    v_mov_b32 v13, 0
    v_mov_b32 v14, 0
    v_mov_b32 v15, 0
    v_mov_b32 v16, 0
    v_mov_b32 v17, 0
    v_mov_b32 v18, 0
    v_mov_b32 v19, 0
    s_lshl_b32 s12, s60, 15
    s_lshl_b32 s13, s61, 11
    s_add_u32 s13, s13, s12
    v_lshl_add_u32 v9, v1, 4, s13
    s_lshl_b32 s13, s61, 13
    s_add_u32 s13, s13, s12
    v_lshl_add_u32 v10, v1, 4, s13
    v_mov_b32 v39, 153088
    s_cmp_lg_u32 s60, 0
    s_cbranch_scc1 gated_mix__ssm_conv_s5__ssm_conv_s4__prompt_kernel_RL48
    s_waitcnt vmcnt(6)
    s_mov_b64 exec, 1
    s_cmp_lg_u32 s0, s1
    s_cbranch_scc1 gated_mix__ssm_conv_s5__ssm_conv_s4__prompt_kernel_RL50
    global_store_dwordx4 v2, v[4:7], s[58:59]
    s_mov_b64 exec, -1
    s_branch gated_mix__ssm_conv_s5__ssm_conv_s4__prompt_kernel_RL49
gated_mix__ssm_conv_s5__ssm_conv_s4__prompt_kernel_RL50:
    global_store_dwordx4 v2, v[4:7], s[58:59] sc1
    s_mov_b64 exec, -1
    s_branch gated_mix__ssm_conv_s5__ssm_conv_s4__prompt_kernel_RL49
gated_mix__ssm_conv_s5__ssm_conv_s4__prompt_kernel_RL48:
    v_mov_b32 v38, 6
    s_waitcnt vmcnt(7)
    ds_write_b32 v2, v38
    s_mov_b32 s11, 1048576
gated_mix__ssm_conv_s5__ssm_conv_s4__prompt_kernel_PW51:
    ds_read_b128 v[32:35], v39 offset:0
    s_waitcnt lgkmcnt(0)
    v_min3_u32 v32, v32, v33, v34
    v_min_u32 v32, v32, v35
    s_sub_u32 s11, s11, 1
    v_readfirstlane_b32 s14, v32
    s_cmp_eq_u32 s11, 0
    s_cbranch_scc1 gated_mix__ssm_conv_s5__ssm_conv_s4__prompt_kernel_PD52
    s_cmp_lt_u32 s14, 7
    s_cbranch_scc1 gated_mix__ssm_conv_s5__ssm_conv_s4__prompt_kernel_PW51
gated_mix__ssm_conv_s5__ssm_conv_s4__prompt_kernel_PD52:
gated_mix__ssm_conv_s5__ssm_conv_s4__prompt_kernel_RL49:
    s_mov_b32 s11, 1048576
gated_mix__ssm_conv_s5__ssm_conv_s4__prompt_kernel_PW53:
    ds_read_b128 v[32:35], v39 offset:16
    s_waitcnt lgkmcnt(0)
    v_min3_u32 v32, v32, v33, v34
    v_min_u32 v32, v32, v35
    s_sub_u32 s11, s11, 1
    v_readfirstlane_b32 s14, v32
    s_cmp_eq_u32 s11, 0
    s_cbranch_scc1 gated_mix__ssm_conv_s5__ssm_conv_s4__prompt_kernel_PD54
    s_cmp_lt_u32 s14, 6
    s_cbranch_scc1 gated_mix__ssm_conv_s5__ssm_conv_s4__prompt_kernel_PW53
gated_mix__ssm_conv_s5__ssm_conv_s4__prompt_kernel_PD54:
    s_cmp_lt_u32 s3, 6
    s_cbranch_scc1 gated_mix__ssm_conv_s5__ssm_conv_s4__prompt_kernel_NP55
    global_load_dword v4, v62, s[58:59] sc1
gated_mix__ssm_conv_s5__ssm_conv_s4__prompt_kernel_NP55:
    ds_read_b128 v[128:131], v52 offset:0
    ds_read_b128 v[132:135], v52 offset:4096
    ds_read_b128 v[136:139], v52 offset:8192
    ds_read_b128 v[140:143], v52 offset:12288
    ds_read_b128 v[144:147], v52 offset:16384
    ds_read_b128 v[148:151], v52 offset:20480
    ds_read_b128 v[152:155], v52 offset:24576
    ds_read_b128 v[156:159], v52 offset:28672
    ds_read_b128 v[160:163], v53 offset:0
    ds_read_b128 v[164:167], v53 offset:4096
    ds_read_b128 v[168:171], v53 offset:8192
    ds_read_b128 v[172:175], v53 offset:12288
    ds_read_b128 v[176:179], v53 offset:16384
    ds_read_b128 v[180:183], v53 offset:20480
    ds_read_b128 v[184:187], v53 offset:24576
    ds_read_b128 v[188:191], v53 offset:28672
    ds_read_b128 v[192:195], v54 offset:0
    ds_read_b128 v[196:199], v54 offset:4096
    ds_read_b128 v[200:203], v54 offset:8192
    ds_read_b128 v[204:207], v54 offset:12288
    ds_read_b128 v[208:211], v54 offset:16384
    ds_read_b128 v[212:215], v54 offset:20480
    ds_read_b128 v[216:219], v54 offset:24576
    ds_read_b128 v[220:223], v54 offset:28672
    ds_read_b128 v[224:227], v55 offset:0
    ds_read_b128 v[228:231], v55 offset:4096
    ds_read_b128 v[232:235], v55 offset:8192
    ds_read_b128 v[236:239], v55 offset:12288
    ds_read_b128 v[240:243], v55 offset:16384
    ds_read_b128 v[244:247], v55 offset:20480
    ds_read_b128 v[248:251], v55 offset:24576
    ds_read_b128 v[252:255], v55 offset:28672
    s_waitcnt vmcnt(0)
    v_lshlrev_b32 v32, 16, v40
    v_and_b32 v33, 0xffff0000, v40
    v_lshlrev_b32 v34, 16, v44
    v_and_b32 v35, 0xffff0000, v44
    v_lshlrev_b32 v36, 16, v48
    v_and_b32 v37, 0xffff0000, v48
    v_mul_f32 v34, v32, v34
    v_mul_f32 v35, v33, v35
    v_mul_f32 v36, v32, v36
    v_mul_f32 v37, v33, v37
    v_cvt_pk_bf16_f32 v34, v34, v35
    v_cvt_pk_bf16_f32 v28, v36, v37
    v_lshlrev_b32 v20, 16, v34
    v_and_b32 v21, 0xffff0000, v34
    v_lshlrev_b32 v32, 16, v41
    v_and_b32 v33, 0xffff0000, v41
    v_lshlrev_b32 v34, 16, v45
    v_and_b32 v35, 0xffff0000, v45
    v_lshlrev_b32 v36, 16, v49
    v_and_b32 v37, 0xffff0000, v49
    v_mul_f32 v34, v32, v34
    v_mul_f32 v35, v33, v35
    v_mul_f32 v36, v32, v36
    v_mul_f32 v37, v33, v37
    v_cvt_pk_bf16_f32 v34, v34, v35
    v_cvt_pk_bf16_f32 v29, v36, v37
    v_lshlrev_b32 v22, 16, v34
    v_and_b32 v23, 0xffff0000, v34
    v_lshlrev_b32 v32, 16, v42
    v_and_b32 v33, 0xffff0000, v42
    v_lshlrev_b32 v34, 16, v46
    v_and_b32 v35, 0xffff0000, v46
    v_lshlrev_b32 v36, 16, v50
    v_and_b32 v37, 0xffff0000, v50
    v_mul_f32 v34, v32, v34
    v_mul_f32 v35, v33, v35
    v_mul_f32 v36, v32, v36
    v_mul_f32 v37, v33, v37
    v_cvt_pk_bf16_f32 v34, v34, v35
    v_cvt_pk_bf16_f32 v30, v36, v37
    v_lshlrev_b32 v24, 16, v34
    v_and_b32 v25, 0xffff0000, v34
    v_lshlrev_b32 v32, 16, v43
    v_and_b32 v33, 0xffff0000, v43
    v_lshlrev_b32 v34, 16, v47
    v_and_b32 v35, 0xffff0000, v47
    v_lshlrev_b32 v36, 16, v51
    v_and_b32 v37, 0xffff0000, v51
    v_mul_f32 v34, v32, v34
    v_mul_f32 v35, v33, v35
    v_mul_f32 v36, v32, v36
    v_mul_f32 v37, v33, v37
    v_cvt_pk_bf16_f32 v34, v34, v35
    v_cvt_pk_bf16_f32 v31, v36, v37
    v_lshlrev_b32 v26, 16, v34
    v_and_b32 v27, 0xffff0000, v34
    v_xor_b32 v40, 0, v56
    v_xor_b32 v41, 32768, v56
    v_xor_b32 v42, 2048, v56
    v_xor_b32 v43, 34816, v56
    v_xor_b32 v44, 4096, v56
    v_xor_b32 v45, 36864, v56
    v_xor_b32 v46, 6144, v56
    v_xor_b32 v47, 38912, v56
    s_cmp_lt_u32 s3, 6
    s_cbranch_scc1 gated_mix__ssm_conv_s5__ssm_conv_s4__prompt_kernel_SD58
    s_mov_b32 s11, 1048576
gated_mix__ssm_conv_s5__ssm_conv_s4__prompt_kernel_SP56:
    s_waitcnt vmcnt(0)
    v_cmp_ne_u32 vcc, s10, v4
    s_and_b64 exec, exec, vcc
    s_cbranch_scc0 gated_mix__ssm_conv_s5__ssm_conv_s4__prompt_kernel_SD57
    s_sub_u32 s11, s11, 1
    s_cmp_eq_u32 s11, 0
    s_cbranch_scc1 gated_mix__ssm_conv_s5__ssm_conv_s4__prompt_kernel_SD57
    global_load_dword v4, v62, s[58:59] sc1
    s_branch gated_mix__ssm_conv_s5__ssm_conv_s4__prompt_kernel_SP56
gated_mix__ssm_conv_s5__ssm_conv_s4__prompt_kernel_SD57:
    s_mov_b64 exec, -1
    s_cmp_eq_u32 s3, 7
    s_cbranch_scc1 gated_mix__ssm_conv_s5__ssm_conv_s4__prompt_kernel_SD58
    s_mov_b32 m0, 153120
    s_add_u32 s15, s68, 6291456
    buffer_load_dwordx4 v63, s[64:67], s15 offen sc1 lds
    s_mov_b32 m0, 154144
    s_add_u32 s15, s68, 6324224
    buffer_load_dwordx4 v61, s[64:67], s15 offen sc1 lds
    s_mov_b32 m0, 155168
    s_add_u32 s15, s68, 6356992
    buffer_load_dwordx4 v63, s[64:67], s15 offen sc1 lds
    s_mov_b32 m0, 156192
    s_add_u32 s15, s68, 6389760
    buffer_load_dwordx4 v61, s[64:67], s15 offen sc1 lds
    s_mov_b32 m0, 157216
    s_add_u32 s15, s68, 6422528
    buffer_load_dwordx4 v63, s[64:67], s15 offen sc1 lds
    s_mov_b32 m0, 158240
    s_add_u32 s15, s68, 6455296
    buffer_load_dwordx4 v61, s[64:67], s15 offen sc1 lds
    s_mov_b32 m0, 159264
    s_add_u32 s15, s68, 6488064
    buffer_load_dwordx4 v63, s[64:67], s15 offen sc1 lds
    s_mov_b32 m0, 160288
    s_add_u32 s15, s68, 6520832
    buffer_load_dwordx4 v61, s[64:67], s15 offen sc1 lds
    s_waitcnt vmcnt(0)
gated_mix__ssm_conv_s5__ssm_conv_s4__prompt_kernel_SD58:
    s_waitcnt lgkmcnt(0)
    s_setprio 0
    s_barrier
    global_load_dwordx4 v[64:67], v40, s[58:59] offset:0 sc1
    global_load_dwordx4 v[68:71], v41, s[58:59] offset:0 sc1
    global_load_dwordx2 v[4:5], v60, s[58:59] sc1
    global_load_dwordx4 v[72:75], v40, s[58:59] offset:1024 sc1
    global_load_dwordx4 v[76:79], v41, s[58:59] offset:1024 sc1
    global_load_dwordx4 v[80:83], v42, s[58:59] offset:0 sc1
    global_load_dwordx4 v[84:87], v43, s[58:59] offset:0 sc1
    global_load_dwordx4 v[88:91], v42, s[58:59] offset:1024 sc1
    global_load_dwordx4 v[92:95], v43, s[58:59] offset:1024 sc1
    global_load_dwordx4 v[96:99], v44, s[58:59] offset:0 sc1
    global_load_dwordx4 v[100:103], v45, s[58:59] offset:0 sc1
    global_load_dwordx4 v[104:107], v44, s[58:59] offset:1024 sc1
    global_load_dwordx4 v[108:111], v45, s[58:59] offset:1024 sc1
    global_load_dwordx4 v[112:115], v46, s[58:59] offset:0 sc1
    global_load_dwordx4 v[116:119], v47, s[58:59] offset:0 sc1
    global_load_dwordx4 v[120:123], v46, s[58:59] offset:1024 sc1
    global_load_dwordx4 v[124:127], v47, s[58:59] offset:1024 sc1
    ds_read_u16_d16_hi v12, v11 offset:0
    ds_read_u16_d16_hi v13, v11 offset:128
    ds_read_u16_d16_hi v14, v11 offset:256
    ds_read_u16_d16_hi v15, v11 offset:384
    ds_read_u16_d16_hi v16, v11 offset:2048
    ds_read_u16_d16_hi v17, v11 offset:2176
    ds_read_u16_d16_hi v18, v11 offset:2304
    ds_read_u16_d16_hi v19, v11 offset:2432
    s_waitcnt vmcnt(15)
    v_mfma_f32_16x16x32_bf16 v[32:35], v[128:131], v[64:67], 0
    v_mfma_f32_16x16x32_bf16 v[48:51], v[128:131], v[68:71], 0
    v_mfma_f32_16x16x32_bf16 v[36:39], v[132:135], v[64:67], 0
    v_mfma_f32_16x16x32_bf16 v[52:55], v[132:135], v[68:71], 0
    v_mfma_f32_16x16x32_bf16 v[40:43], v[136:139], v[64:67], 0
    v_mfma_f32_16x16x32_bf16 v[56:59], v[136:139], v[68:71], 0
    v_mfma_f32_16x16x32_bf16 v[44:47], v[140:143], v[64:67], 0
    v_mfma_f32_16x16x32_bf16 v[60:63], v[140:143], v[68:71], 0
    s_waitcnt vmcnt(12)
    v_mfma_f32_16x16x32_bf16 v[32:35], v[144:147], v[72:75], v[32:35]
    v_mfma_f32_16x16x32_bf16 v[48:51], v[144:147], v[76:79], v[48:51]
    v_mfma_f32_16x16x32_bf16 v[36:39], v[148:151], v[72:75], v[36:39]
    v_mfma_f32_16x16x32_bf16 v[52:55], v[148:151], v[76:79], v[52:55]
    v_mfma_f32_16x16x32_bf16 v[40:43], v[152:155], v[72:75], v[40:43]
    v_mfma_f32_16x16x32_bf16 v[56:59], v[152:155], v[76:79], v[56:59]
    v_mfma_f32_16x16x32_bf16 v[44:47], v[156:159], v[72:75], v[44:47]
    v_mfma_f32_16x16x32_bf16 v[60:63], v[156:159], v[76:79], v[60:63]
    v_and_b32 v2, 2, v1
    s_waitcnt lgkmcnt(0)
    v_cmp_eq_u32 vcc, 0, v2
    s_nop 1
    v_cndmask_b32 v3, v5, v4, vcc
    v_sub_f32 v2, 1.0, v3
    v_cvt_pk_bf16_f32 v2, v2, v2
    v_and_b32 v2, 0xffff0000, v2
    s_waitcnt vmcnt(10)
    v_mfma_f32_16x16x32_bf16 v[32:35], v[160:163], v[80:83], v[32:35]
    v_mfma_f32_16x16x32_bf16 v[48:51], v[160:163], v[84:87], v[48:51]
    v_mfma_f32_16x16x32_bf16 v[36:39], v[164:167], v[80:83], v[36:39]
    v_mfma_f32_16x16x32_bf16 v[52:55], v[164:167], v[84:87], v[52:55]
    v_mfma_f32_16x16x32_bf16 v[40:43], v[168:171], v[80:83], v[40:43]
    v_mfma_f32_16x16x32_bf16 v[56:59], v[168:171], v[84:87], v[56:59]
    v_mfma_f32_16x16x32_bf16 v[44:47], v[172:175], v[80:83], v[44:47]
    v_mfma_f32_16x16x32_bf16 v[60:63], v[172:175], v[84:87], v[60:63]
    v_lshlrev_b32 v4, 16, v28
    v_and_b32 v5, 0xffff0000, v28
    v_add_f32 v4, v4, v12
    v_add_f32 v5, v5, v13
    v_cvt_pk_bf16_f32 v4, v4, v5
    v_and_b32 v5, 0xffff0000, v4
    v_lshlrev_b32 v4, 16, v4
    v_mul_f32 v4, v2, v4
    v_mul_f32 v5, v2, v5
    v_cvt_pk_bf16_f32 v4, v4, v5
    v_lshlrev_b32 v12, 16, v4
    v_and_b32 v13, 0xffff0000, v4
    s_waitcnt vmcnt(8)
    v_mfma_f32_16x16x32_bf16 v[32:35], v[176:179], v[88:91], v[32:35]
    v_mfma_f32_16x16x32_bf16 v[48:51], v[176:179], v[92:95], v[48:51]
    v_mfma_f32_16x16x32_bf16 v[36:39], v[180:183], v[88:91], v[36:39]
    v_mfma_f32_16x16x32_bf16 v[52:55], v[180:183], v[92:95], v[52:55]
    v_mfma_f32_16x16x32_bf16 v[40:43], v[184:187], v[88:91], v[40:43]
    v_mfma_f32_16x16x32_bf16 v[56:59], v[184:187], v[92:95], v[56:59]
    v_mfma_f32_16x16x32_bf16 v[44:47], v[188:191], v[88:91], v[44:47]
    v_mfma_f32_16x16x32_bf16 v[60:63], v[188:191], v[92:95], v[60:63]
    v_lshlrev_b32 v4, 16, v29
    v_and_b32 v5, 0xffff0000, v29
    v_add_f32 v4, v4, v14
    v_add_f32 v5, v5, v15
    v_cvt_pk_bf16_f32 v4, v4, v5
    v_and_b32 v5, 0xffff0000, v4
    v_lshlrev_b32 v4, 16, v4
    v_mul_f32 v4, v2, v4
    v_mul_f32 v5, v2, v5
    v_cvt_pk_bf16_f32 v4, v4, v5
    v_lshlrev_b32 v14, 16, v4
    v_and_b32 v15, 0xffff0000, v4
    s_waitcnt vmcnt(6)
    v_mfma_f32_16x16x32_bf16 v[32:35], v[192:195], v[96:99], v[32:35]
    v_mfma_f32_16x16x32_bf16 v[48:51], v[192:195], v[100:103], v[48:51]
    v_mfma_f32_16x16x32_bf16 v[36:39], v[196:199], v[96:99], v[36:39]
    v_mfma_f32_16x16x32_bf16 v[52:55], v[196:199], v[100:103], v[52:55]
    v_mfma_f32_16x16x32_bf16 v[40:43], v[200:203], v[96:99], v[40:43]
    v_mfma_f32_16x16x32_bf16 v[56:59], v[200:203], v[100:103], v[56:59]
    v_mfma_f32_16x16x32_bf16 v[44:47], v[204:207], v[96:99], v[44:47]
    v_mfma_f32_16x16x32_bf16 v[60:63], v[204:207], v[100:103], v[60:63]
    v_lshlrev_b32 v4, 16, v30
    v_and_b32 v5, 0xffff0000, v30
    v_add_f32 v4, v4, v16
    v_add_f32 v5, v5, v17
    v_cvt_pk_bf16_f32 v4, v4, v5
    v_and_b32 v5, 0xffff0000, v4
    v_lshlrev_b32 v4, 16, v4
    v_mul_f32 v4, v2, v4
    v_mul_f32 v5, v2, v5
    v_cvt_pk_bf16_f32 v4, v4, v5
    v_lshlrev_b32 v16, 16, v4
    v_and_b32 v17, 0xffff0000, v4
    s_waitcnt vmcnt(4)
    v_mfma_f32_16x16x32_bf16 v[32:35], v[208:211], v[104:107], v[32:35]
    v_mfma_f32_16x16x32_bf16 v[48:51], v[208:211], v[108:111], v[48:51]
    v_mfma_f32_16x16x32_bf16 v[36:39], v[212:215], v[104:107], v[36:39]
    v_mfma_f32_16x16x32_bf16 v[52:55], v[212:215], v[108:111], v[52:55]
    v_mfma_f32_16x16x32_bf16 v[40:43], v[216:219], v[104:107], v[40:43]
    v_mfma_f32_16x16x32_bf16 v[56:59], v[216:219], v[108:111], v[56:59]
    v_mfma_f32_16x16x32_bf16 v[44:47], v[220:223], v[104:107], v[44:47]
    v_mfma_f32_16x16x32_bf16 v[60:63], v[220:223], v[108:111], v[60:63]
    v_lshlrev_b32 v4, 16, v31
    v_and_b32 v5, 0xffff0000, v31
    v_add_f32 v4, v4, v18
    v_add_f32 v5, v5, v19
    v_cvt_pk_bf16_f32 v4, v4, v5
    v_and_b32 v5, 0xffff0000, v4
    v_lshlrev_b32 v4, 16, v4
    v_mul_f32 v4, v2, v4
    v_mul_f32 v5, v2, v5
    v_cvt_pk_bf16_f32 v4, v4, v5
    v_lshlrev_b32 v18, 16, v4
    v_and_b32 v19, 0xffff0000, v4
    s_waitcnt vmcnt(2)
    v_mfma_f32_16x16x32_bf16 v[32:35], v[224:227], v[112:115], v[32:35]
    v_mfma_f32_16x16x32_bf16 v[48:51], v[224:227], v[116:119], v[48:51]
    v_mfma_f32_16x16x32_bf16 v[36:39], v[228:231], v[112:115], v[36:39]
    v_mfma_f32_16x16x32_bf16 v[52:55], v[228:231], v[116:119], v[52:55]
    v_mfma_f32_16x16x32_bf16 v[40:43], v[232:235], v[112:115], v[40:43]
    v_mfma_f32_16x16x32_bf16 v[56:59], v[232:235], v[116:119], v[56:59]
    v_mfma_f32_16x16x32_bf16 v[44:47], v[236:239], v[112:115], v[44:47]
    v_mfma_f32_16x16x32_bf16 v[60:63], v[236:239], v[116:119], v[60:63]
    s_waitcnt vmcnt(0)
    v_mfma_f32_16x16x32_bf16 v[32:35], v[240:243], v[120:123], v[32:35]
    v_mfma_f32_16x16x32_bf16 v[48:51], v[240:243], v[124:127], v[48:51]
    v_mfma_f32_16x16x32_bf16 v[36:39], v[244:247], v[120:123], v[36:39]
    v_mfma_f32_16x16x32_bf16 v[52:55], v[244:247], v[124:127], v[52:55]
    v_mfma_f32_16x16x32_bf16 v[40:43], v[248:251], v[120:123], v[40:43]
    v_mfma_f32_16x16x32_bf16 v[56:59], v[248:251], v[124:127], v[56:59]
    v_mfma_f32_16x16x32_bf16 v[44:47], v[252:255], v[120:123], v[44:47]
    v_mfma_f32_16x16x32_bf16 v[60:63], v[252:255], v[124:127], v[60:63]
    s_nop 0
    ds_write_b128 v9, v[32:35] offset:0
    s_nop 0
    ds_write_b128 v9, v[36:39] offset:1024
    ds_write_b128 v9, v[48:51] offset:8192
    ds_write_b128 v9, v[52:55] offset:9216
    ds_write_b128 v9, v[40:43] offset:16384
    ds_write_b128 v9, v[44:47] offset:17408
    ds_write_b128 v9, v[56:59] offset:24576
    ds_write_b128 v9, v[60:63] offset:25600
    s_waitcnt lgkmcnt(0)
    s_barrier
    ds_read_b128 v[64:67], v10 offset:0
    ds_read_b128 v[68:71], v10 offset:1024
    ds_read_b128 v[72:75], v10 offset:2048
    ds_read_b128 v[76:79], v10 offset:3072
    ds_read_b128 v[80:83], v10 offset:4096
    ds_read_b128 v[84:87], v10 offset:5120
    ds_read_b128 v[88:91], v10 offset:6144
    ds_read_b128 v[92:95], v10 offset:7168
    s_waitcnt lgkmcnt(6)
    v_add_f32 v20, v20, v64
    v_add_f32 v21, v21, v65
    v_add_f32 v22, v22, v66
    v_add_f32 v23, v23, v67
    v_add_f32 v24, v24, v68
    v_add_f32 v25, v25, v69
    v_add_f32 v26, v26, v70
    v_add_f32 v27, v27, v71
    s_waitcnt lgkmcnt(4)
    v_add_f32 v20, v20, v72
    v_add_f32 v21, v21, v73
    v_add_f32 v22, v22, v74
    v_add_f32 v23, v23, v75
    v_add_f32 v24, v24, v76
    v_add_f32 v25, v25, v77
    v_add_f32 v26, v26, v78
    v_add_f32 v27, v27, v79
    s_waitcnt lgkmcnt(2)
    v_add_f32 v20, v20, v80
    v_add_f32 v21, v21, v81
    v_add_f32 v22, v22, v82
    v_add_f32 v23, v23, v83
    v_add_f32 v24, v24, v84
    v_add_f32 v25, v25, v85
    v_add_f32 v26, v26, v86
    v_add_f32 v27, v27, v87
    s_waitcnt lgkmcnt(0)
    v_add_f32 v20, v20, v88
    v_add_f32 v21, v21, v89
    v_add_f32 v22, v22, v90
    v_add_f32 v23, v23, v91
    v_add_f32 v24, v24, v92
    v_add_f32 v25, v25, v93
    v_add_f32 v26, v26, v94
    v_add_f32 v27, v27, v95
    v_fma_f32 v96, v3, v20, v12
    v_fma_f32 v97, v3, v21, v13
    v_fma_f32 v98, v3, v22, v14
    v_fma_f32 v99, v3, v23, v15
    global_store_dwordx4 v8, v[96:99], s[54:55] offset:0 nt
    v_fma_f32 v100, v3, v24, v16
    v_fma_f32 v101, v3, v25, v17
    v_fma_f32 v102, v3, v26, v18
    v_fma_f32 v103, v3, v27, v19
    global_store_dwordx4 v8, v[100:103], s[54:55] offset:64 nt
gated_mix__ssm_conv_s5__ssm_conv_s4__prompt_kernel_END:
s_endpgm
.section .rodata,"a"
.p2align 6
.amdhsa_kernel gated_mix__ssm_conv_s5__ssm_conv_s4__prompt_kernel
  .amdhsa_next_free_vgpr 256
  .amdhsa_next_free_sgpr 102
  .amdhsa_accum_offset 256
  .amdhsa_group_segment_fixed_size 0
  .amdhsa_kernarg_size 176
  .amdhsa_user_sgpr_count 2
  .amdhsa_user_sgpr_kernarg_segment_ptr 1
  .amdhsa_system_sgpr_workgroup_id_x 1
.end_amdhsa_kernel
```
